```python
import torch

def _softmax(x, axis=-1):
    return torch.softmax(x, dim=axis)
def _gelu(x):
    return torch.nn.functional.gelu(x, approximate="tanh")
def _silu(x):
    return torch.nn.functional.silu(x)
def _sigmoid(x):
    return torch.sigmoid(x)
def _layernorm(x, axis=-1, eps=1e-5):
    m = x.mean(dim=axis, keepdim=True)
    v = x.var(dim=axis, keepdim=True, unbiased=False)
    return (x - m) / torch.sqrt(v + eps)
def _scatter_add(tgt, idx, src, axis=0):
    return tgt.clone().index_add_(axis, idx, src)
def _segment_sum(src, seg, n):
    out = torch.zeros((n,) + src.shape[1:], dtype=src.dtype)
    return out.index_add_(0, seg, src)
def _pad(x, pw):
    flat = tuple(v for pair in reversed(pw) for v in pair)
    return torch.nn.functional.pad(x, flat)

kernel_name = 'gated_mix__softmax_full_mha__sliding_local_dilated__prompt'

def setup_inputs():

    _w = (lambda a: (lambda t: t.to(torch.bfloat16) if t.is_floating_point() else t)(torch.as_tensor(a)))
    def _A_setup():
        B, S, D = 1, 2048, 640
        return {
            "x": _w((lambda *s: torch.randn(*s, dtype=torch.bfloat16) * 0.05)(B, S, D)),
            "wqkv": _w((lambda *s: torch.randn(*s, dtype=torch.bfloat16) * 1.6)(D, 3 * D)),
            "wo": _w((lambda *s: torch.randn(*s, dtype=torch.bfloat16) * 0.1)(D, D)),
        }
    _A_in = _A_setup()

    def _B_setup():
        B, S, D = 1, 2048, 640
        return {
            "x": _w((lambda *s: torch.randn(*s, dtype=torch.bfloat16) * 0.05)(B, S, D)),
            "wqkv": _w((lambda *s: torch.randn(*s, dtype=torch.bfloat16) * 1.6)(D, 3 * D)),
            "wo": _w((lambda *s: torch.randn(*s, dtype=torch.bfloat16) * 0.05)(D, D)),
        }
    _B_in = _B_setup()

    return {
        "A_x": _A_in["x"],
        "A_wqkv": _A_in["wqkv"],
        "A_wo": _A_in["wo"],
        "B_x": _B_in["x"],
        "B_wqkv": _B_in["wqkv"],
        "B_wo": _B_in["wo"],
        "gate_w": _w((lambda *s: torch.randn(*s, dtype=torch.bfloat16) * 0.05)(640) * 16.0),
    }

def reference(A_x, A_wqkv, A_wo, B_x, B_wqkv, B_wo, gate_w):
    def _A_ref(x, wqkv, wo):
        B, S, D = x.shape
        H = 32; Dh = D // H
        qkv = (lambda x, *d: x.permute(*d))((x @ wqkv).reshape(B, S, 3, H, Dh), 2, 0, 3, 1, 4)
        q, k, v = qkv[0], qkv[1], qkv[2]
        scale = Dh ** -0.5
        scores = torch.einsum("bhqd,bhkd->bhqk", q, k) * scale
        p = _softmax(scores, axis=-1)
        o = torch.einsum("bhqk,bhkd->bhqd", p, v)
        return (lambda x, *d: x.permute(*d))(o, 0, 2, 1, 3).reshape(B, S, D) @ wo

    def _B_ref(x, wqkv, wo):
        B, S, D = x.shape
        H = 32; Dh = D // H
        W, dil = 8, 2
        qkv = (lambda x, *d: x.permute(*d))((x @ wqkv).reshape(B, S, 3, H, Dh), 2, 0, 3, 1, 4)
        q, k, v = qkv[0], qkv[1], qkv[2]
        scale = Dh ** -0.5
        pos = torch.arange(S)
        off = torch.arange(W) * dil
        idx = pos[:, None] - off[None, :]
        mask = idx >= 0
        idx_c = torch.where(mask, idx, 0).reshape(-1)
        kg = k[:, :, idx_c, :].reshape(B, H, S, W, Dh)
        vg = v[:, :, idx_c, :].reshape(B, H, S, W, Dh)
        logits = torch.einsum("bhsd,bhswd->bhsw", q, kg) * scale
        logits = torch.where(mask[None, None, :, :], logits, -1e9)
        attn = _softmax(logits, axis=-1)
        o = torch.einsum("bhsw,bhswd->bhsd", attn, vg)
        return (lambda x, *d: x.permute(*d))(o, 0, 2, 1, 3).reshape(B, S, D) @ wo

    x = A_x
    g = _sigmoid((x * gate_w).sum(-1, keepdims=True))
    a = _A_ref(x, A_wqkv, A_wo)
    b = _B_ref(x, B_wqkv, B_wo)
    return g * a + (1 - g) * b
```

```asm
; @launch grid=(256,1,1) block=(512,1,1) lds=163840
.amdgcn_target "amdgcn-amd-amdhsa--gfx950"
.text
.globl gated_mix__softmax_full_mha__sliding_local_dilated__prompt_kernel
.p2align 8
.type gated_mix__softmax_full_mha__sliding_local_dilated__prompt_kernel,@function
gated_mix__softmax_full_mha__sliding_local_dilated__prompt_kernel:
  s_cmp_ge_u32 s2, 256
  s_cbranch_scc1 gated_mix__softmax_full_mha__sliding_local_dilated__prompt_kernel_end
  s_cmp_ge_u32 s2, 8
  s_cbranch_scc1 gated_mix__softmax_full_mha__sliding_local_dilated__prompt_kernel_tce_done
  s_getpc_b64 s[92:93]
gated_mix__softmax_full_mha__sliding_local_dilated__prompt_kernel_tce:
  s_sub_u32 s92, s92, gated_mix__softmax_full_mha__sliding_local_dilated__prompt_kernel_tce-gated_mix__softmax_full_mha__sliding_local_dilated__prompt_kernel
  s_subb_u32 s93, s93, 0
  v_lshlrev_b32 v254, 7, v0
  v_min_u32 v254, text_end-gated_mix__softmax_full_mha__sliding_local_dilated__prompt_kernel-4, v254
  global_load_dword v255, v254, s[92:93]
gated_mix__softmax_full_mha__sliding_local_dilated__prompt_kernel_tce_done:
  s_load_dwordx2 s[100:101], s[0:1], 64
  s_load_dwordx2 s[4:5], s[0:1], 0
  s_load_dwordx2 s[6:7], s[0:1], 8
  s_load_dwordx2 s[30:31], s[0:1], 32
  s_load_dwordx2 s[36:37], s[0:1], 72
  s_load_dwordx2 s[38:39], s[0:1], 48
  v_lshrrev_b32 v1, 6, v0
  v_and_b32 v2, 63, v0
  v_readfirstlane_b32 s20, v1
  s_and_b32 s24, s2, 7
  s_lshr_b32 s25, s2, 3
  s_lshr_b32 s26, s24, 1
  s_and_b32 s27, s24, 1
  s_cmp_eq_u32 s27, 0
  s_cbranch_scc0 gated_mix__softmax_full_mha__sliding_local_dilated__prompt_kernel_odd
  s_and_b32 s23, s25, 7
  s_lshr_b32 s32, s25, 3
  s_branch gated_mix__softmax_full_mha__sliding_local_dilated__prompt_kernel_map
gated_mix__softmax_full_mha__sliding_local_dilated__prompt_kernel_odd:
  s_mul_i32 s32, s25, 37
  s_lshr_b32 s32, s32, 8
  s_mul_i32 s33, s32, 7
  s_sub_u32 s33, s25, s33
  s_add_u32 s23, s33, 8
  s_cmp_ge_u32 s25, 28
  s_cselect_b32 s23, 15, s23
gated_mix__softmax_full_mha__sliding_local_dilated__prompt_kernel_map:
  s_lshl_b32 s26, s26, 2
  s_add_u32 s22, s26, s32
  s_cmp_eq_u32 s23, 15
  s_cbranch_scc1 gated_mix__softmax_full_mha__sliding_local_dilated__prompt_kernel_slow
  s_cmp_ge_u32 s20, 4
  s_cbranch_scc1 gated_mix__softmax_full_mha__sliding_local_dilated__prompt_kernel_loader
gated_mix__softmax_full_mha__sliding_local_dilated__prompt_kernel_slow:
  s_waitcnt lgkmcnt(0)
  s_mov_b32 s8, s4
  s_mov_b32 s9, s5
  s_mov_b32 s10, 2621440
  s_mov_b32 s11, 0x20000
  s_mov_b32 s16, s36
  s_mov_b32 s17, s37
  s_mov_b32 s18, 268435456
  s_mov_b32 s19, 0x20000
  s_mov_b32 s48, s38
  s_mov_b32 s49, s39
  s_mov_b32 s50, 1280
  s_mov_b32 s51, 0x20000
  s_cmp_ge_u32 s20, 4
  s_cbranch_scc1 gated_mix__softmax_full_mha__sliding_local_dilated__prompt_kernel_ones
  s_lshl_b32 s90, s2, 2
  s_add_u32 s90, s90, s20
  s_lshl_b32 s90, s90, 4
  v_bfe_u32 v3, v2, 1, 4
  v_add_u32 v3, s90, v3
  v_and_b32 v4, 7, v3
  v_mul_u32_u24 v4, 384, v4
  v_bfe_u32 v5, v3, 3, 6
  v_mul_u32_u24 v5, 5632, v5
  v_bfe_u32 v6, v3, 9, 4
  s_mov_b32 s91, 360448
  v_mul_lo_u32 v6, v6, s91
  v_add3_u32 v4, v4, v5, v6
  v_lshrrev_b32 v5, 13, v3
  s_mov_b32 s91, 6291456
  v_mul_lo_u32 v5, v5, s91
  v_add_u32 v4, v4, v5
  s_mov_b32 s91, 6294336
  v_and_b32 v5, 1, v2
  v_lshlrev_b32 v6, 4, v5
  v_add_u32 v4, v4, v6
  v_subrev_u32 v5, 1, v5
  v_and_b32 v8, 0x3f803f80, v5
  v_and_b32 v9, 0x3f803f80, v5
  v_and_b32 v10, 0x3f803f80, v5
  v_and_b32 v11, 0x3f803f80, v5
  s_mov_b32 exec_hi, 0
  buffer_store_dwordx4 v[8:11], v4, s[16:19], s91 offen sc1
  s_mov_b64 exec, -1
gated_mix__softmax_full_mha__sliding_local_dilated__prompt_kernel_ones:
  s_cmp_eq_u32 s23, 15
  s_cbranch_scc1 gated_mix__softmax_full_mha__sliding_local_dilated__prompt_kernel_gate
  s_and_b32 s24, s20, 1
  s_lshr_b32 s25, s20, 1
  v_and_b32 v3, 31, v2
  s_lshl_b32 s26, s24, 6
  v_add_u32 v4, s26, v3
  v_lshlrev_b32 v4, 7, v4
  v_lshrrev_b32 v5, 5, v2
  v_bfe_u32 v6, v2, 1, 3
  v_xor_b32 v6, v5, v6
  v_lshlrev_b32 v6, 4, v6
  v_add_u32 v16, v4, v6
  v_xor_b32 v17, 32, v16
  v_xor_b32 v18, 64, v16
  v_xor_b32 v19, 96, v16
  v_bfe_u32 v6, v2, 2, 2
  v_lshlrev_b32 v7, 3, v5
  v_add_u32 v7, v7, v6
  v_lshlrev_b32 v7, 8, v7
  s_lshl_b32 s26, s25, 1
  v_xor_b32 v12, s26, v6
  v_lshlrev_b32 v12, 6, v12
  v_bfe_u32 v13, v2, 4, 1
  v_lshlrev_b32 v13, 5, v13
  v_and_b32 v14, 3, v2
  v_lshlrev_b32 v14, 3, v14
  v_add3_u32 v7, v7, v12, v13
  v_add_u32 v7, v7, v14
  v_add_u32 v20, 16384, v7
  v_xor_b32 v21, 64, v20
  s_lshl_b32 s33, s22, 2
  s_lshl_b32 s34, s24, 1
  s_add_u32 s33, s33, s34
  s_cmp_ge_u32 s23, 10
  s_cbranch_scc1 gated_mix__softmax_full_mha__sliding_local_dilated__prompt_kernel_vaddr
  s_mov_b32 s26, 360448
  s_mov_b32 s67, 5632
  s_mov_b32 s68, 6291456
  s_mov_b32 s69, 12582912
  s_cmp_lt_u32 s23, 5
  s_cselect_b32 s41, 0x3ea52b5c, 1.0
  s_cselect_b32 s26, 163840, s26
  s_cselect_b32 s67, 2560, s67
  s_cselect_b32 s68, 0, s68
  s_cselect_b32 s69, 3145728, s69
  s_cselect_b32 s30, 0, 5
  s_sub_u32 s30, s23, s30
  s_mul_i32 s33, s33, s67
  s_lshl_b32 s30, s30, 4
  s_lshl_b32 s32, s25, 3
  s_add_u32 s30, s30, s32
  v_lshlrev_b32 v3, 4, v3
  v_add_u32 v3, s33, v3
  v_add_u32 v5, s30, v5
  s_movk_i32 s35, 205
  v_add_u32 v6, 0, v5
  v_mul_u32_u24 v7, s35, v6
  v_lshrrev_b32 v7, 10, v7
  v_mul_u32_u24 v4, 5, v7
  v_sub_u32 v6, v6, v4
  v_lshlrev_b32 v6, 9, v6
  v_mul_lo_u32 v7, v7, s26
  v_add3_u32 v240, v3, v6, v7
  v_add_u32 v6, 2, v5
  v_mul_u32_u24 v7, s35, v6
  v_lshrrev_b32 v7, 10, v7
  v_mul_u32_u24 v4, 5, v7
  v_sub_u32 v6, v6, v4
  v_lshlrev_b32 v6, 9, v6
  v_mul_lo_u32 v7, v7, s26
  v_add3_u32 v241, v3, v6, v7
  v_add_u32 v6, 4, v5
  v_mul_u32_u24 v7, s35, v6
  v_lshrrev_b32 v7, 10, v7
  v_mul_u32_u24 v4, 5, v7
  v_sub_u32 v6, v6, v4
  v_lshlrev_b32 v6, 9, v6
  v_mul_lo_u32 v7, v7, s26
  v_add3_u32 v242, v3, v6, v7
  v_add_u32 v6, 6, v5
  v_mul_u32_u24 v7, s35, v6
  v_lshrrev_b32 v7, 10, v7
  v_mul_u32_u24 v4, 5, v7
  v_sub_u32 v6, v6, v4
  v_lshlrev_b32 v6, 9, v6
  v_mul_lo_u32 v7, v7, s26
  v_add3_u32 v243, v3, v6, v7
  v_mov_b32 v186, s41
  v_mov_b32 v187, s41
  s_mov_b32 s94, 0
  s_branch gated_mix__softmax_full_mha__sliding_local_dilated__prompt_kernel_addr_done
gated_mix__softmax_full_mha__sliding_local_dilated__prompt_kernel_vaddr:
  s_mov_b32 s67, 5632
  s_mov_b32 s68, 6294016
  s_mov_b32 s69, 12585472
  s_mul_i32 s33, s33, 5632
  s_sub_u32 s30, s23, 10
  s_lshl_b32 s30, s30, 7
  s_lshl_b32 s32, s25, 6
  s_add_u32 s30, s30, s32
  v_add_u32 v3, s30, v3
  v_mul_u32_u24 v5, 384, v5
  v_add_u32 v5, s33, v5
  s_mov_b32 s35, 52429
  s_mov_b32 s26, 360448
  s_movk_i32 s27, 1536
  v_add_u32 v6, 0, v3
  v_mul_u32_u24 v7, s35, v6
  v_lshrrev_b32 v7, 20, v7
  v_mul_u32_u24 v4, 20, v7
  v_sub_u32 v242, v6, v4
  v_and_b32 v4, 1, v7
  v_lshrrev_b32 v7, 1, v7
  v_mul_lo_u32 v7, v7, s26
  v_mad_u32_u24 v7, v4, s27, v7
  v_lshlrev_b32 v6, 4, v242
  v_add3_u32 v240, v5, v6, v7
  v_add_u32 v6, 32, v3
  v_mul_u32_u24 v7, s35, v6
  v_lshrrev_b32 v7, 20, v7
  v_mul_u32_u24 v4, 20, v7
  v_sub_u32 v243, v6, v4
  v_and_b32 v4, 1, v7
  v_lshrrev_b32 v7, 1, v7
  v_mul_lo_u32 v7, v7, s26
  v_mad_u32_u24 v7, v4, s27, v7
  v_lshlrev_b32 v6, 4, v243
  v_add3_u32 v241, v5, v6, v7
  s_mov_b32 s41, 0
  v_mov_b32 v182, 0x3f803f80
  v_mov_b32 v183, 0x3f803f80
  v_mov_b32 v184, 0x3f803f80
  v_mov_b32 v185, 0x3f803f80
  s_mov_b32 s94, 1
gated_mix__softmax_full_mha__sliding_local_dilated__prompt_kernel_addr_done:
  s_mov_b32 s3, 0
  v_mov_b32 v8, 147456
  v_mov_b32 v9, 0
  ds_write_b32 v8, v9
  s_and_b32 s8, s2, 7
  s_lshr_b32 s9, s2, 3
  s_and_b32 s10, s9, 1
  s_lshl_b32 s8, s8, 1
  s_add_u32 s21, s8, s10
  s_lshr_b32 s22, s9, 1
  s_and_b32 s23, s20, 1
  s_bfe_u32 s24, s20, 0x10001
  s_lshr_b32 s25, s20, 2
  s_mov_b32 s32, -1
  s_mov_b32 s33, 0
  s_cmp_eq_u32 s23, 0
  s_cselect_b32 s34, -1, 0
  s_cselect_b32 s35, 0, -1
  v_and_b32 v8, 31, v2
  v_lshrrev_b32 v9, 5, v2
  s_mul_i32 s10, s21, 360448
  s_add_u32 s26, s10, 6291456
  s_mul_i32 s9, s23, 1536
  v_lshlrev_b32 v10, 4, v8
  v_lshlrev_b32 v11, 9, v9
  v_add3_u32 v244, v10, v11, s9
  v_lshlrev_b32 v12, 3, v9
  v_add_u32 v12, v10, v12
  v_add_u32 v245, 1024, v12
  s_mul_i32 s9, s23, 1536
  v_mul_u32_u24 v11, 384, v9
  v_min_u32 v13, 21, v8
  v_lshlrev_b32 v13, 4, v13
  v_add3_u32 v13, v13, v11, s9
  v_add_u32 v0, 2560, v13
  s_mul_i32 s9, s25, 22528
  v_add_u32 v3, s9, v244
  v_add_u32 v4, s9, v245
  v_add_u32 v5, s9, v0
  s_lshl_b32 s28, s20, 10
  v_lshlrev_b32 v12, 4, v2
  v_add_u32 v6, s28, v12
  s_lshl_b32 s9, s20, 9
  s_add_u32 s38, s9, 40960
  v_add_u32 v7, s38, v12
  s_lshl_b32 s8, s22, 2
  s_lshl_b32 s9, s24, 1
  s_add_u32 s8, s8, s9
  s_add_u32 s39, s8, s25
  s_mul_i32 s8, s39, 2560
  s_mul_i32 s9, s21, 163840
  s_add_u32 s8, s8, s9
  s_add_u32 s8, s8, 18874368
  s_lshl_b32 s9, s23, 10
  s_add_u32 s9, s9, s8
  v_lshlrev_b32 v11, 9, v9
  v_add3_u32 v14, v10, v11, s9
  s_lshl_b32 s9, s23, 8
  s_add_u32 s9, s9, s8
  s_add_u32 s9, s9, 2048
  v_lshrrev_b32 v11, 1, v10
  v_add_u32 v1, s9, v11
  s_mul_i32 s8, s20, 3328
  s_add_u32 s8, s8, 0
  v_add_u32 v15, s8, v12
  s_lshl_b32 s8, s39, 5
  v_add_u32 v10, s8, v8
  v_lshlrev_b32 v10, 2, v10
  v_add_u32 v216, 25165824, v10
  s_lshl_b32 s8, s22, 7
  s_lshl_b32 s9, s25, 6
  s_add_u32 s8, s8, s9
  s_add_u32 s8, s8, s24
  v_lshlrev_b32 v10, 1, v8
  v_add_u32 v10, s8, v10
  v_lshlrev_b32 v10, 2, v10
  v_add_u32 v227, 25165824, v10
  v_cndmask_b32 v228, 0, -1, s[34:35]
  v_lshlrev_b32 v10, 2, v9
  v_sub_u32 v10, v8, v10
  v_mov_b32 v13, 0xf149f2ca
  v_subrev_u32 v11, 0, v10
  v_cmp_gt_u32 s[50:51], 8, v11
  v_subrev_u32 v12, 1, v10
  v_cmp_gt_u32 s[52:53], 8, v12
  v_subrev_u32 v11, 2, v10
  v_cmp_gt_u32 s[54:55], 8, v11
  v_subrev_u32 v12, 3, v10
  v_cmp_gt_u32 s[56:57], 8, v12
  v_cndmask_b32 v166, v13, 0, s[50:51]
  v_cndmask_b32 v167, v13, 0, s[52:53]
  v_cndmask_b32 v168, v13, 0, s[54:55]
  v_cndmask_b32 v169, v13, 0, s[56:57]
  v_subrev_u32 v11, 8, v10
  v_cmp_gt_u32 s[50:51], 8, v11
  v_subrev_u32 v12, 9, v10
  v_cmp_gt_u32 s[52:53], 8, v12
  v_subrev_u32 v11, 10, v10
  v_cmp_gt_u32 s[54:55], 8, v11
  v_subrev_u32 v12, 11, v10
  v_cmp_gt_u32 s[56:57], 8, v12
  v_cndmask_b32 v170, v13, 0, s[50:51]
  v_cndmask_b32 v171, v13, 0, s[52:53]
  v_cndmask_b32 v172, v13, 0, s[54:55]
  v_cndmask_b32 v173, v13, 0, s[56:57]
  v_subrev_u32 v11, 16, v10
  v_cmp_gt_u32 s[50:51], 8, v11
  v_subrev_u32 v12, 17, v10
  v_cmp_gt_u32 s[52:53], 8, v12
  v_subrev_u32 v11, 18, v10
  v_cmp_gt_u32 s[54:55], 8, v11
  v_subrev_u32 v12, 19, v10
  v_cmp_gt_u32 s[56:57], 8, v12
  v_cndmask_b32 v174, v13, 0, s[50:51]
  v_cndmask_b32 v175, v13, 0, s[52:53]
  v_cndmask_b32 v176, v13, 0, s[54:55]
  v_cndmask_b32 v177, v13, 0, s[56:57]
  v_subrev_u32 v11, 24, v10
  v_cmp_gt_u32 s[50:51], 8, v11
  v_subrev_u32 v12, 25, v10
  v_cmp_gt_u32 s[52:53], 8, v12
  v_subrev_u32 v11, 26, v10
  v_cmp_gt_u32 s[54:55], 8, v11
  v_subrev_u32 v12, 27, v10
  v_cmp_gt_u32 s[56:57], 8, v12
  v_cndmask_b32 v178, v13, 0, s[50:51]
  v_cndmask_b32 v179, v13, 0, s[52:53]
  v_cndmask_b32 v180, v13, 0, s[54:55]
  v_cndmask_b32 v181, v13, 0, s[56:57]
  s_cmp_eq_u32 s25, 1
  s_cselect_b32 s9, 1, 3
  s_cmp_lt_u32 s39, s9
  s_cselect_b32 s9, 1000, 0
  v_add_u32 v11, s9, v10
  v_cmp_gt_i32 s[50:51], 0, v11
  v_cmp_gt_i32 s[52:53], 1, v11
  v_cmp_gt_i32 s[54:55], 2, v11
  v_cmp_gt_i32 s[56:57], 3, v11
  v_cndmask_b32 v194, v13, 0, s[50:51]
  v_cndmask_b32 v195, v13, 0, s[52:53]
  v_cndmask_b32 v196, v13, 0, s[54:55]
  v_cndmask_b32 v197, v13, 0, s[56:57]
  v_mov_b32 v206, 0
  v_mov_b32 v207, 0
  s_load_dwordx2 s[4:5], s[0:1], 16
  s_load_dwordx2 s[6:7], s[0:1], 40
  s_load_dwordx2 s[36:37], s[0:1], 56
  s_and_b32 s8, s2, 7
  s_lshr_b32 s9, s2, 3
  s_lshr_b32 s10, s8, 1
  s_lshl_b32 s10, s10, 3
  s_lshr_b32 s11, s9, 2
  s_add_u32 s42, s10, s11
  s_and_b32 s8, s8, 1
  s_lshl_b32 s8, s8, 2
  s_and_b32 s9, s9, 3
  s_add_u32 s43, s8, s9
  s_and_b32 s48, s20, 1
  s_lshr_b32 s49, s20, 1
  s_waitcnt lgkmcnt(0)
  s_mov_b32 s60, s4
  s_mov_b32 s61, s5
  s_mov_b32 s62, 819200
  s_mov_b32 s63, 0x20000
  s_mov_b32 s44, s6
  s_mov_b32 s45, s7
  s_mov_b32 s46, 819200
  s_mov_b32 s47, 0x20000
  s_mov_b32 s96, s36
  s_mov_b32 s97, s37
  s_mov_b32 s98, 2621440
  s_mov_b32 s99, 0x20000
  v_and_b32 v8, 31, v2
  v_lshrrev_b32 v9, 5, v2
  v_mul_u32_u24 v10, 43, v2
  v_lshrrev_b32 v10, 9, v10
  v_mul_u32_u24 v11, 12, v10
  v_sub_u32 v11, v2, v11
  s_mul_i32 s8, s20, 40
  v_add_u32 v12, s8, v10
  s_movk_i32 s9, 1280
  s_mul_i32 s10, s43, 160
  v_lshlrev_b32 v13, 4, v11
  v_add_u32 v13, s10, v13
  v_mad_u32_u24 v221, v12, s9, v13
  v_cmp_gt_u32 s[50:51], 10, v11
  v_cmp_gt_u32 s[52:53], 60, v2
  s_nop 3
  s_and_b64 s[58:59], s[50:51], s[52:53]
  s_mul_i32 s65, s20, 7680
  v_bfe_u32 v10, v2, 2, 2
  s_mul_i32 s8, s49, 80
  v_add_u32 v10, s8, v10
  v_bfe_u32 v11, v2, 4, 1
  v_lshlrev_b32 v11, 5, v11
  v_and_b32 v12, 3, v2
  v_lshlrev_b32 v12, 3, v12
  v_add_u32 v11, v11, v12
  v_lshlrev_b32 v12, 2, v9
  v_add_u32 v12, v10, v12
  v_mul_u32_u24 v12, 192, v12
  v_add_u32 v12, v12, v11
  v_add_u32 v217, 102400, v12
  v_add_u32 v219, 26624, v12
  v_mul_u32_u24 v12, 40, v9
  v_add3_u32 v12, v10, v12, 16
  v_mul_u32_u24 v12, 192, v12
  v_add_u32 v12, v12, v11
  v_add_u32 v218, 102400, v12
  v_add_u32 v220, 26624, v12
  s_mul_i32 s8, s49, 327680
  s_add_u32 s8, s8, 18874368
  s_lshl_b32 s9, s42, 1
  s_add_u32 s9, s9, s48
  s_mul_i32 s10, s9, 2560
  s_add_u32 s10, s10, s8
  v_lshlrev_b32 v10, 4, v8
  v_lshlrev_b32 v11, 9, v9
  v_add3_u32 v223, v10, v11, s10
  s_mov_b32 s11, 163840
  v_mul_lo_u32 v12, v9, s11
  s_add_u32 s10, s10, 2048
  v_lshrrev_b32 v13, 1, v10
  v_add3_u32 v224, v13, v12, s10
  s_lshr_b32 s10, s42, 1
  s_lshl_b32 s10, s10, 2
  s_and_b32 s13, s42, 1
  s_add_u32 s10, s10, s13
  s_mul_i32 s10, s10, 2560
  s_add_u32 s10, s10, s8
  s_lshl_b32 s13, s48, 8
  s_add_u32 s10, s10, s13
  s_add_u32 s10, s10, 2621440
  v_lshrrev_b32 v10, 1, v8
  v_and_b32 v13, 1, v8
  v_mul_u32_u24 v13, 5120, v13
  v_add_u32 v12, v12, v13
  v_add_u32 v11, v11, v13
  v_lshlrev_b32 v13, 4, v10
  v_add3_u32 v225, v13, v11, s10
  s_lshl_b32 s13, s48, 7
  s_sub_u32 s10, s10, s13
  s_add_u32 s10, s10, 2048
  v_lshlrev_b32 v13, 3, v10
  v_add3_u32 v226, v13, v12, s10
  s_lshl_b32 s10, s9, 5
  v_add_u32 v10, s10, v8
  s_mul_i32 s10, s43, 160
  s_lshl_b32 s11, s49, 4
  s_add_u32 s10, s10, s11
  v_mul_u32_u24 v10, 1280, v10
  v_add_u32 v222, s10, v10
  s_lshr_b32 s64, s42, 1
  s_load_dwordx2 s[4:5], s[0:1], 0
  s_load_dwordx2 s[8:9], s[0:1], 8
  s_load_dwordx2 s[12:13], s[0:1], 32
  s_waitcnt lgkmcnt(0)
  s_mov_b32 s6, 2621440
  s_mov_b32 s7, 0x20000
  s_mov_b32 s10, 2457600
  s_mov_b32 s11, 0x20000
  s_mov_b32 s14, 2457600
  s_mov_b32 s15, 0x20000
  s_waitcnt lgkmcnt(0)
  s_lshr_b32 s90, s2, 3
  s_lshl_b32 s90, s90, 2
  s_add_u32 s90, s90, s20
  s_lshl_b32 s91, s90, 6
  v_add_u32 v232, s91, v2
  s_and_b32 s91, s2, 1
  s_lshl_b32 s91, s91, 11
  v_lshrrev_b32 v233, 4, v232
  v_and_b32 v234, 15, v232
  v_lshlrev_b32 v234, 7, v234
  v_add_u32 v234, s91, v234
  v_mul_u32_u24 v233, 3840, v233
  v_add_u32 v233, v233, v234
  s_mul_i32 s91, s90, 16
  v_add_u32 v232, s91, v2
  v_lshrrev_b32 v233, 4, v232
  v_mul_u32_u24 v233, 3840, v233
  v_add_u32 v233, v233, v234
  s_mov_b32 s91, 983040
  s_mov_b64 exec, 0xffff
  buffer_load_dword v235, v233, s[8:11], s91 offen
  s_mov_b64 exec, -1
  s_bfe_u32 s91, s2, 0x20001
  s_lshl_b32 s91, s91, 9
  s_lshl_b32 s90, s90, 2
  s_add_u32 s91, s91, s90
  v_and_b32 v234, 3, v2
  v_add_u32 v234, s91, v234
  v_mul_u32_u24 v234, 1280, v234
  v_lshrrev_b32 v232, 2, v2
  v_lshlrev_b32 v232, 7, v232
  v_add_u32 v234, v234, v232
  s_movk_i32 s91, 512
  s_mov_b64 exec, 0xff
  buffer_load_dword v236, v234, s[4:7], s91 offen
  s_mov_b64 exec, -1
  s_barrier
  ds_read_b128 v[24:27], v16 offset:0
  ds_read_b128 v[28:31], v16 offset:4096
  ds_read_b64_tr_b16 v[32:33], v20 offset:0
  ds_read_b64_tr_b16 v[34:35], v20 offset:1024
  ds_read_b64_tr_b16 v[36:37], v21 offset:0
  ds_read_b64_tr_b16 v[38:39], v21 offset:1024
  ds_read_b128 v[40:43], v17 offset:0
  ds_read_b128 v[44:47], v17 offset:4096
  ds_read_b64_tr_b16 v[48:49], v20 offset:4096
  ds_read_b64_tr_b16 v[50:51], v20 offset:5120
  ds_read_b64_tr_b16 v[52:53], v21 offset:4096
  ds_read_b64_tr_b16 v[54:55], v21 offset:5120
  s_lshr_b32 s90, s2, 3
  s_lshl_b32 s90, s90, 2
  s_add_u32 s90, s90, s20
  s_lshl_b32 s91, s90, 6
  v_add_u32 v246, s91, v2
  s_and_b32 s91, s2, 1
  s_lshl_b32 s91, s91, 11
  v_lshrrev_b32 v247, 4, v246
  v_and_b32 v248, 15, v246
  v_lshlrev_b32 v248, 7, v248
  v_add_u32 v248, s91, v248
  v_mul_u32_u24 v247, 3840, v247
  v_add_u32 v247, v247, v248
  s_mul_i32 s91, s90, 32
  v_add_u32 v246, s91, v2
  v_lshrrev_b32 v247, 4, v246
  v_mul_u32_u24 v247, 3840, v247
  v_add_u32 v247, v247, v248
  s_mov_b32 s91, 1474560
  s_mov_b32 exec_hi, 0
  buffer_load_dword v249, v247, s[8:11], s91 offen
  s_mov_b64 exec, -1
  s_bfe_u32 s91, s2, 0x20001
  s_lshl_b32 s91, s91, 9
  s_lshl_b32 s90, s90, 2
  s_add_u32 s91, s91, s90
  v_and_b32 v248, 3, v2
  v_add_u32 v248, s91, v248
  v_mul_u32_u24 v248, 1280, v248
  v_lshrrev_b32 v246, 2, v2
  v_lshlrev_b32 v246, 7, v246
  v_add_u32 v248, v248, v246
  s_movk_i32 s91, 768
  s_mov_b64 exec, 0xffff
  buffer_load_dword v250, v248, s[4:7], s91 offen
  s_mov_b64 exec, -1
  s_cmp_eq_u32 s94, 1
  s_cbranch_scc1 gated_mix__softmax_full_mha__sliding_local_dilated__prompt_kernel_vmode
gated_mix__softmax_full_mha__sliding_local_dilated__prompt_kernel_qk_prob:
  s_mov_b32 s40, 0
  s_waitcnt lgkmcnt(6)
  v_mfma_f32_32x32x16_bf16 v[88:103], v[32:35], v[24:27], 0
  ds_read_b128 v[56:59], v18 offset:0
  ds_read_b128 v[60:63], v18 offset:4096
  v_mfma_f32_32x32x16_bf16 v[104:119], v[36:39], v[24:27], 0
  ds_read_b64_tr_b16 v[64:65], v20 offset:8192
  ds_read_b64_tr_b16 v[66:67], v20 offset:9216
  v_mfma_f32_32x32x16_bf16 v[120:135], v[32:35], v[28:31], 0
  ds_read_b64_tr_b16 v[68:69], v21 offset:8192
  v_mfma_f32_32x32x16_bf16 v[136:151], v[36:39], v[28:31], 0
  ds_read_b64_tr_b16 v[70:71], v21 offset:9216
  s_branch gated_mix__softmax_full_mha__sliding_local_dilated__prompt_kernel_qk_in
  .p2align 6
gated_mix__softmax_full_mha__sliding_local_dilated__prompt_kernel_qk_loop:
  s_waitcnt lgkmcnt(6)
  v_mfma_f32_32x32x16_bf16 v[88:103], v[32:35], v[24:27], v[88:103]
  ds_read_b128 v[56:59], v18 offset:0
  ds_read_b128 v[60:63], v18 offset:4096
  v_mfma_f32_32x32x16_bf16 v[104:119], v[36:39], v[24:27], v[104:119]
  ds_read_b64_tr_b16 v[64:65], v20 offset:8192
  ds_read_b64_tr_b16 v[66:67], v20 offset:9216
  v_mfma_f32_32x32x16_bf16 v[120:135], v[32:35], v[28:31], v[120:135]
  ds_read_b64_tr_b16 v[68:69], v21 offset:8192
  v_mfma_f32_32x32x16_bf16 v[136:151], v[36:39], v[28:31], v[136:151]
  ds_read_b64_tr_b16 v[70:71], v21 offset:9216
gated_mix__softmax_full_mha__sliding_local_dilated__prompt_kernel_qk_in:
  s_waitcnt lgkmcnt(6)
  v_mfma_f32_32x32x16_bf16 v[88:103], v[48:51], v[40:43], v[88:103]
  ds_read_b128 v[72:75], v19 offset:0
  ds_read_b128 v[76:79], v19 offset:4096
  v_mfma_f32_32x32x16_bf16 v[104:119], v[52:55], v[40:43], v[104:119]
  ds_read_b64_tr_b16 v[80:81], v20 offset:12288
  ds_read_b64_tr_b16 v[82:83], v20 offset:13312
  v_mfma_f32_32x32x16_bf16 v[120:135], v[48:51], v[44:47], v[120:135]
  ds_read_b64_tr_b16 v[84:85], v21 offset:12288
  v_mfma_f32_32x32x16_bf16 v[136:151], v[52:55], v[44:47], v[136:151]
  ds_read_b64_tr_b16 v[86:87], v21 offset:13312
  s_waitcnt lgkmcnt(6)
  v_mfma_f32_32x32x16_bf16 v[88:103], v[64:67], v[56:59], v[88:103]
  v_mfma_f32_32x32x16_bf16 v[104:119], v[68:71], v[56:59], v[104:119]
  v_mfma_f32_32x32x16_bf16 v[120:135], v[64:67], v[60:63], v[120:135]
  v_mfma_f32_32x32x16_bf16 v[136:151], v[68:71], v[60:63], v[136:151]
  s_waitcnt lgkmcnt(0)
  s_barrier
  v_mfma_f32_32x32x16_bf16 v[88:103], v[80:83], v[72:75], v[88:103]
  ds_read_b128 v[24:27], v16 offset:32768
  ds_read_b128 v[28:31], v16 offset:36864
  ds_read_b64_tr_b16 v[32:33], v20 offset:32768
  v_mfma_f32_32x32x16_bf16 v[104:119], v[84:87], v[72:75], v[104:119]
  ds_read_b64_tr_b16 v[34:35], v20 offset:33792
  ds_read_b64_tr_b16 v[36:37], v21 offset:32768
  ds_read_b64_tr_b16 v[38:39], v21 offset:33792
  v_mfma_f32_32x32x16_bf16 v[120:135], v[80:83], v[76:79], v[120:135]
  ds_read_b128 v[40:43], v17 offset:32768
  ds_read_b128 v[44:47], v17 offset:36864
  ds_read_b64_tr_b16 v[48:49], v20 offset:36864
  v_mfma_f32_32x32x16_bf16 v[136:151], v[84:87], v[76:79], v[136:151]
  ds_read_b64_tr_b16 v[50:51], v20 offset:37888
  ds_read_b64_tr_b16 v[52:53], v21 offset:36864
  ds_read_b64_tr_b16 v[54:55], v21 offset:37888
  s_waitcnt lgkmcnt(6)
  v_mfma_f32_32x32x16_bf16 v[88:103], v[32:35], v[24:27], v[88:103]
  ds_read_b128 v[56:59], v18 offset:32768
  ds_read_b128 v[60:63], v18 offset:36864
  v_mfma_f32_32x32x16_bf16 v[104:119], v[36:39], v[24:27], v[104:119]
  ds_read_b64_tr_b16 v[64:65], v20 offset:40960
  ds_read_b64_tr_b16 v[66:67], v20 offset:41984
  v_mfma_f32_32x32x16_bf16 v[120:135], v[32:35], v[28:31], v[120:135]
  ds_read_b64_tr_b16 v[68:69], v21 offset:40960
  v_mfma_f32_32x32x16_bf16 v[136:151], v[36:39], v[28:31], v[136:151]
  ds_read_b64_tr_b16 v[70:71], v21 offset:41984
  s_waitcnt lgkmcnt(6)
  v_mfma_f32_32x32x16_bf16 v[88:103], v[48:51], v[40:43], v[88:103]
  ds_read_b128 v[72:75], v19 offset:32768
  ds_read_b128 v[76:79], v19 offset:36864
  v_mfma_f32_32x32x16_bf16 v[104:119], v[52:55], v[40:43], v[104:119]
  ds_read_b64_tr_b16 v[80:81], v20 offset:45056
  ds_read_b64_tr_b16 v[82:83], v20 offset:46080
  v_mfma_f32_32x32x16_bf16 v[120:135], v[48:51], v[44:47], v[120:135]
  ds_read_b64_tr_b16 v[84:85], v21 offset:45056
  v_mfma_f32_32x32x16_bf16 v[136:151], v[52:55], v[44:47], v[136:151]
  ds_read_b64_tr_b16 v[86:87], v21 offset:46080
  s_waitcnt lgkmcnt(6)
  v_mfma_f32_32x32x16_bf16 v[88:103], v[64:67], v[56:59], v[88:103]
  v_mfma_f32_32x32x16_bf16 v[104:119], v[68:71], v[56:59], v[104:119]
  v_mfma_f32_32x32x16_bf16 v[120:135], v[64:67], v[60:63], v[120:135]
  v_mfma_f32_32x32x16_bf16 v[136:151], v[68:71], v[60:63], v[136:151]
  s_waitcnt lgkmcnt(0)
  s_barrier
  v_xor_b32 v16, 65536, v16
  v_xor_b32 v17, 65536, v17
  v_xor_b32 v18, 65536, v18
  v_xor_b32 v19, 65536, v19
  v_xor_b32 v20, 65536, v20
  v_xor_b32 v21, 65536, v21
  v_mfma_f32_32x32x16_bf16 v[88:103], v[80:83], v[72:75], v[88:103]
  ds_read_b128 v[24:27], v16 offset:0
  ds_read_b128 v[28:31], v16 offset:4096
  ds_read_b64_tr_b16 v[32:33], v20 offset:0
  v_mfma_f32_32x32x16_bf16 v[104:119], v[84:87], v[72:75], v[104:119]
  ds_read_b64_tr_b16 v[34:35], v20 offset:1024
  ds_read_b64_tr_b16 v[36:37], v21 offset:0
  ds_read_b64_tr_b16 v[38:39], v21 offset:1024
  v_mfma_f32_32x32x16_bf16 v[120:135], v[80:83], v[76:79], v[120:135]
  ds_read_b128 v[40:43], v17 offset:0
  ds_read_b128 v[44:47], v17 offset:4096
  ds_read_b64_tr_b16 v[48:49], v20 offset:4096
  v_mfma_f32_32x32x16_bf16 v[136:151], v[84:87], v[76:79], v[136:151]
  ds_read_b64_tr_b16 v[50:51], v20 offset:5120
  ds_read_b64_tr_b16 v[52:53], v21 offset:4096
  ds_read_b64_tr_b16 v[54:55], v21 offset:5120
  s_lshl_b32 s90, s3, 3
  s_add_u32 s90, s90, s40
  s_cmp_eq_u32 s90, 8
  s_cbranch_scc1 gated_mix__softmax_full_mha__sliding_local_dilated__prompt_kernel_qk_pub
  s_cmp_eq_u32 s90, 1
  s_cbranch_scc1 gated_mix__softmax_full_mha__sliding_local_dilated__prompt_kernel_qk_tb
gated_mix__softmax_full_mha__sliding_local_dilated__prompt_kernel_qk_pub_back:
  s_add_u32 s40, s40, 1
  s_cmp_lt_u32 s40, 5
  s_cbranch_scc1 gated_mix__softmax_full_mha__sliding_local_dilated__prompt_kernel_qk_loop
  s_cmp_eq_u32 s3, 1
  s_cbranch_scc1 gated_mix__softmax_full_mha__sliding_local_dilated__prompt_kernel_qk_last
  v_mov_b32 v13, 0
  global_load_dword v12, v13, s[100:101] sc1
  s_nop 7
  s_nop 3
  v_pk_mul_f32 v[88:89], v[88:89], v[186:187]
  v_pk_mul_f32 v[90:91], v[90:91], v[186:187]
  v_pk_mul_f32 v[92:93], v[92:93], v[186:187]
  v_pk_mul_f32 v[94:95], v[94:95], v[186:187]
  v_pk_mul_f32 v[96:97], v[96:97], v[186:187]
  v_pk_mul_f32 v[98:99], v[98:99], v[186:187]
  v_pk_mul_f32 v[100:101], v[100:101], v[186:187]
  v_pk_mul_f32 v[102:103], v[102:103], v[186:187]
  v_cvt_pk_bf16_f32 v198, v88, v89
  v_cvt_pk_bf16_f32 v199, v90, v91
  v_cvt_pk_bf16_f32 v200, v92, v93
  v_cvt_pk_bf16_f32 v201, v94, v95
  v_cvt_pk_bf16_f32 v202, v96, v97
  v_cvt_pk_bf16_f32 v203, v98, v99
  v_cvt_pk_bf16_f32 v204, v100, v101
  v_cvt_pk_bf16_f32 v205, v102, v103
  v_permlane32_swap_b32 v198, v200
  v_permlane32_swap_b32 v199, v201
  v_permlane32_swap_b32 v202, v204
  v_permlane32_swap_b32 v203, v205
  buffer_store_dwordx4 v[198:201], v240, s[16:19], s68 offen sc1
  buffer_store_dwordx4 v[202:205], v241, s[16:19], s68 offen sc1
  v_pk_mul_f32 v[104:105], v[104:105], v[186:187]
  v_pk_mul_f32 v[106:107], v[106:107], v[186:187]
  v_pk_mul_f32 v[108:109], v[108:109], v[186:187]
  v_pk_mul_f32 v[110:111], v[110:111], v[186:187]
  v_pk_mul_f32 v[112:113], v[112:113], v[186:187]
  v_pk_mul_f32 v[114:115], v[114:115], v[186:187]
  v_pk_mul_f32 v[116:117], v[116:117], v[186:187]
  v_pk_mul_f32 v[118:119], v[118:119], v[186:187]
  v_cvt_pk_bf16_f32 v208, v104, v105
  v_cvt_pk_bf16_f32 v209, v106, v107
  v_cvt_pk_bf16_f32 v210, v108, v109
  v_cvt_pk_bf16_f32 v211, v110, v111
  v_cvt_pk_bf16_f32 v212, v112, v113
  v_cvt_pk_bf16_f32 v213, v114, v115
  v_cvt_pk_bf16_f32 v214, v116, v117
  v_cvt_pk_bf16_f32 v215, v118, v119
  v_permlane32_swap_b32 v208, v210
  v_permlane32_swap_b32 v209, v211
  v_permlane32_swap_b32 v212, v214
  v_permlane32_swap_b32 v213, v215
  buffer_store_dwordx4 v[208:211], v242, s[16:19], s68 offen sc1
  buffer_store_dwordx4 v[212:215], v243, s[16:19], s68 offen sc1
  v_pk_mul_f32 v[120:121], v[120:121], v[186:187]
  v_pk_mul_f32 v[122:123], v[122:123], v[186:187]
  v_pk_mul_f32 v[124:125], v[124:125], v[186:187]
  v_pk_mul_f32 v[126:127], v[126:127], v[186:187]
  v_pk_mul_f32 v[128:129], v[128:129], v[186:187]
  v_pk_mul_f32 v[130:131], v[130:131], v[186:187]
  v_pk_mul_f32 v[132:133], v[132:133], v[186:187]
  v_pk_mul_f32 v[134:135], v[134:135], v[186:187]
  v_cvt_pk_bf16_f32 v198, v120, v121
  v_cvt_pk_bf16_f32 v199, v122, v123
  v_cvt_pk_bf16_f32 v200, v124, v125
  v_cvt_pk_bf16_f32 v201, v126, v127
  v_cvt_pk_bf16_f32 v202, v128, v129
  v_cvt_pk_bf16_f32 v203, v130, v131
  v_cvt_pk_bf16_f32 v204, v132, v133
  v_cvt_pk_bf16_f32 v205, v134, v135
  v_permlane32_swap_b32 v198, v200
  v_permlane32_swap_b32 v199, v201
  v_permlane32_swap_b32 v202, v204
  v_permlane32_swap_b32 v203, v205
  s_add_u32 s68, s68, s67
  buffer_store_dwordx4 v[198:201], v240, s[16:19], s68 offen sc1
  buffer_store_dwordx4 v[202:205], v241, s[16:19], s68 offen sc1
  v_pk_mul_f32 v[136:137], v[136:137], v[186:187]
  v_pk_mul_f32 v[138:139], v[138:139], v[186:187]
  v_pk_mul_f32 v[140:141], v[140:141], v[186:187]
  v_pk_mul_f32 v[142:143], v[142:143], v[186:187]
  v_pk_mul_f32 v[144:145], v[144:145], v[186:187]
  v_pk_mul_f32 v[146:147], v[146:147], v[186:187]
  v_pk_mul_f32 v[148:149], v[148:149], v[186:187]
  v_pk_mul_f32 v[150:151], v[150:151], v[186:187]
  v_cvt_pk_bf16_f32 v208, v136, v137
  v_cvt_pk_bf16_f32 v209, v138, v139
  v_cvt_pk_bf16_f32 v210, v140, v141
  v_cvt_pk_bf16_f32 v211, v142, v143
  v_cvt_pk_bf16_f32 v212, v144, v145
  v_cvt_pk_bf16_f32 v213, v146, v147
  v_cvt_pk_bf16_f32 v214, v148, v149
  v_cvt_pk_bf16_f32 v215, v150, v151
  v_permlane32_swap_b32 v208, v210
  v_permlane32_swap_b32 v209, v211
  v_permlane32_swap_b32 v212, v214
  v_permlane32_swap_b32 v213, v215
  buffer_store_dwordx4 v[208:211], v242, s[16:19], s68 offen sc1
  buffer_store_dwordx4 v[212:215], v243, s[16:19], s68 offen sc1
  s_mov_b32 s3, 1
  s_branch gated_mix__softmax_full_mha__sliding_local_dilated__prompt_kernel_qk_prob
gated_mix__softmax_full_mha__sliding_local_dilated__prompt_kernel_qk_pub:
  s_waitcnt vmcnt(0)
  s_mov_b32 s90, 200000
  v_readfirstlane_b32 s66, v12
  s_nop 3
  s_cmp_lg_u32 s66, 0
  s_cbranch_scc1 gated_mix__softmax_full_mha__sliding_local_dilated__prompt_kernel_n1qk_ok
  v_mov_b32 v13, 0
gated_mix__softmax_full_mha__sliding_local_dilated__prompt_kernel_n1qk:
  global_load_dword v12, v13, s[100:101] sc1
  s_waitcnt vmcnt(0)
  v_readfirstlane_b32 s66, v12
  s_nop 3
  s_cmp_lg_u32 s66, 0
  s_cbranch_scc1 gated_mix__softmax_full_mha__sliding_local_dilated__prompt_kernel_n1qk_ok
  s_sub_u32 s90, s90, 1
  s_cmp_eq_u32 s90, 0
  s_cbranch_scc1 gated_mix__softmax_full_mha__sliding_local_dilated__prompt_kernel_n1qk_ok
  s_sleep 1
  s_branch gated_mix__softmax_full_mha__sliding_local_dilated__prompt_kernel_n1qk
gated_mix__softmax_full_mha__sliding_local_dilated__prompt_kernel_n1qk_ok:
  s_mov_b64 exec, 1
  v_mov_b32 v8, 147456
  v_mov_b32 v9, 1
  ds_add_rtn_u32 v10, v8, v9
  s_waitcnt lgkmcnt(0)
  s_mov_b64 exec, -1
  v_readfirstlane_b32 s91, v10
  s_nop 3
  s_cmp_lg_u32 s91, 3
  s_cbranch_scc1 gated_mix__softmax_full_mha__sliding_local_dilated__prompt_kernel_qk_nopub
  s_lshl_b32 s91, s2, 2
  s_add_u32 s91, s91, 26214400
  v_lshlrev_b32 v9, 10, v2
  v_mov_b32 v8, s66
  s_mov_b32 exec_hi, 0
  buffer_store_dword v8, v9, s[16:19], s91 offen sc1
  s_mov_b64 exec, -1
gated_mix__softmax_full_mha__sliding_local_dilated__prompt_kernel_qk_nopub:
  s_branch gated_mix__softmax_full_mha__sliding_local_dilated__prompt_kernel_qk_pub_back
gated_mix__softmax_full_mha__sliding_local_dilated__prompt_kernel_qk_tb:
  s_lshr_b32 s90, s2, 3
  s_lshl_b32 s90, s90, 2
  s_add_u32 s90, s90, s20
  s_lshl_b32 s91, s90, 6
  v_add_u32 v246, s91, v2
  s_and_b32 s91, s2, 1
  s_lshl_b32 s91, s91, 11
  v_lshrrev_b32 v247, 4, v246
  v_and_b32 v248, 15, v246
  v_lshlrev_b32 v248, 7, v248
  v_add_u32 v248, s91, v248
  v_mul_u32_u24 v247, 3840, v247
  v_add_u32 v247, v247, v248
  s_mul_i32 s91, s90, 80
  v_add_u32 v246, s91, v2
  s_and_b32 s91, s2, 1
  s_lshl_b32 s91, s91, 11
  s_mov_b32 exec_hi, 0xff
  v_lshrrev_b32 v247, 4, v246
  v_and_b32 v248, 15, v246
  v_lshlrev_b32 v248, 7, v248
  v_mul_u32_u24 v247, 3840, v247
  v_add_u32 v247, v247, v248
  buffer_load_dword v249, v247, s[12:15], s91 offen
  v_add_u32 v246, 40, v246
  v_lshrrev_b32 v247, 4, v246
  v_and_b32 v248, 15, v246
  v_lshlrev_b32 v248, 7, v248
  v_mul_u32_u24 v247, 3840, v247
  v_add_u32 v247, v247, v248
  buffer_load_dword v250, v247, s[12:15], s91 offen
  s_mov_b64 exec, -1
  s_branch gated_mix__softmax_full_mha__sliding_local_dilated__prompt_kernel_qk_pub_back
gated_mix__softmax_full_mha__sliding_local_dilated__prompt_kernel_qk_last:
  s_waitcnt lgkmcnt(0)
  s_lshl_b32 s8, s22, 2
  s_lshl_b32 s9, s24, 1
  s_add_u32 s8, s8, s9
  s_mul_i32 s8, s8, 2560
  s_mul_i32 s9, s21, 163840
  s_add_u32 s8, s8, s9
  s_add_u32 s8, s8, 0
  s_add_u32 s9, s8, 2560
  buffer_load_dwordx4 v[16:19], v244, s[16:19], s8 offen sc1
  buffer_load_dwordx2 v[24:25], v245, s[16:19], s8 offen sc1
  buffer_load_dwordx4 v[20:23], v244, s[16:19], s9 offen sc1
  buffer_load_dwordx2 v[26:27], v245, s[16:19], s9 offen sc1
  s_nop 7
  v_pk_mul_f32 v[88:89], v[88:89], v[186:187]
  v_pk_mul_f32 v[90:91], v[90:91], v[186:187]
  v_pk_mul_f32 v[92:93], v[92:93], v[186:187]
  v_pk_mul_f32 v[94:95], v[94:95], v[186:187]
  v_pk_mul_f32 v[96:97], v[96:97], v[186:187]
  v_pk_mul_f32 v[98:99], v[98:99], v[186:187]
  v_pk_mul_f32 v[100:101], v[100:101], v[186:187]
  v_pk_mul_f32 v[102:103], v[102:103], v[186:187]
  v_cvt_pk_bf16_f32 v198, v88, v89
  v_cvt_pk_bf16_f32 v199, v90, v91
  v_cvt_pk_bf16_f32 v200, v92, v93
  v_cvt_pk_bf16_f32 v201, v94, v95
  v_cvt_pk_bf16_f32 v202, v96, v97
  v_cvt_pk_bf16_f32 v203, v98, v99
  v_cvt_pk_bf16_f32 v204, v100, v101
  v_cvt_pk_bf16_f32 v205, v102, v103
  v_permlane32_swap_b32 v198, v200
  v_permlane32_swap_b32 v199, v201
  v_permlane32_swap_b32 v202, v204
  v_permlane32_swap_b32 v203, v205
  buffer_store_dwordx4 v[198:201], v240, s[16:19], s69 offen sc1
  buffer_store_dwordx4 v[202:205], v241, s[16:19], s69 offen sc1
  v_pk_mul_f32 v[104:105], v[104:105], v[186:187]
  v_pk_mul_f32 v[106:107], v[106:107], v[186:187]
  v_pk_mul_f32 v[108:109], v[108:109], v[186:187]
  v_pk_mul_f32 v[110:111], v[110:111], v[186:187]
  v_pk_mul_f32 v[112:113], v[112:113], v[186:187]
  v_pk_mul_f32 v[114:115], v[114:115], v[186:187]
  v_pk_mul_f32 v[116:117], v[116:117], v[186:187]
  v_pk_mul_f32 v[118:119], v[118:119], v[186:187]
  v_cvt_pk_bf16_f32 v208, v104, v105
  v_cvt_pk_bf16_f32 v209, v106, v107
  v_cvt_pk_bf16_f32 v210, v108, v109
  v_cvt_pk_bf16_f32 v211, v110, v111
  v_cvt_pk_bf16_f32 v212, v112, v113
  v_cvt_pk_bf16_f32 v213, v114, v115
  v_cvt_pk_bf16_f32 v214, v116, v117
  v_cvt_pk_bf16_f32 v215, v118, v119
  v_permlane32_swap_b32 v208, v210
  v_permlane32_swap_b32 v209, v211
  v_permlane32_swap_b32 v212, v214
  v_permlane32_swap_b32 v213, v215
  buffer_store_dwordx4 v[208:211], v242, s[16:19], s69 offen sc1
  buffer_store_dwordx4 v[212:215], v243, s[16:19], s69 offen sc1
  v_pk_mul_f32 v[120:121], v[120:121], v[186:187]
  v_pk_mul_f32 v[122:123], v[122:123], v[186:187]
  v_pk_mul_f32 v[124:125], v[124:125], v[186:187]
  v_pk_mul_f32 v[126:127], v[126:127], v[186:187]
  v_pk_mul_f32 v[128:129], v[128:129], v[186:187]
  v_pk_mul_f32 v[130:131], v[130:131], v[186:187]
  v_pk_mul_f32 v[132:133], v[132:133], v[186:187]
  v_pk_mul_f32 v[134:135], v[134:135], v[186:187]
  v_cvt_pk_bf16_f32 v198, v120, v121
  v_cvt_pk_bf16_f32 v199, v122, v123
  v_cvt_pk_bf16_f32 v200, v124, v125
  v_cvt_pk_bf16_f32 v201, v126, v127
  v_cvt_pk_bf16_f32 v202, v128, v129
  v_cvt_pk_bf16_f32 v203, v130, v131
  v_cvt_pk_bf16_f32 v204, v132, v133
  v_cvt_pk_bf16_f32 v205, v134, v135
  v_permlane32_swap_b32 v198, v200
  v_permlane32_swap_b32 v199, v201
  v_permlane32_swap_b32 v202, v204
  v_permlane32_swap_b32 v203, v205
  s_add_u32 s69, s69, s67
  buffer_store_dwordx4 v[198:201], v240, s[16:19], s69 offen sc1
  buffer_store_dwordx4 v[202:205], v241, s[16:19], s69 offen sc1
  v_pk_mul_f32 v[136:137], v[136:137], v[186:187]
  v_pk_mul_f32 v[138:139], v[138:139], v[186:187]
  v_pk_mul_f32 v[140:141], v[140:141], v[186:187]
  v_pk_mul_f32 v[142:143], v[142:143], v[186:187]
  v_pk_mul_f32 v[144:145], v[144:145], v[186:187]
  v_pk_mul_f32 v[146:147], v[146:147], v[186:187]
  v_pk_mul_f32 v[148:149], v[148:149], v[186:187]
  v_pk_mul_f32 v[150:151], v[150:151], v[186:187]
  v_cvt_pk_bf16_f32 v208, v136, v137
  v_cvt_pk_bf16_f32 v209, v138, v139
  v_cvt_pk_bf16_f32 v210, v140, v141
  v_cvt_pk_bf16_f32 v211, v142, v143
  v_cvt_pk_bf16_f32 v212, v144, v145
  v_cvt_pk_bf16_f32 v213, v146, v147
  v_cvt_pk_bf16_f32 v214, v148, v149
  v_cvt_pk_bf16_f32 v215, v150, v151
  v_permlane32_swap_b32 v208, v210
  v_permlane32_swap_b32 v209, v211
  v_permlane32_swap_b32 v212, v214
  v_permlane32_swap_b32 v213, v215
  buffer_store_dwordx4 v[208:211], v242, s[16:19], s69 offen sc1
  buffer_store_dwordx4 v[212:215], v243, s[16:19], s69 offen sc1
  s_branch gated_mix__softmax_full_mha__sliding_local_dilated__prompt_kernel_cdone
gated_mix__softmax_full_mha__sliding_local_dilated__prompt_kernel_vmode:
gated_mix__softmax_full_mha__sliding_local_dilated__prompt_kernel_vv_prob:
  s_mov_b32 s40, 0
  s_waitcnt lgkmcnt(6)
  v_mfma_f32_32x32x16_bf16 v[88:103], v[24:27], v[32:35], 0
  ds_read_b128 v[56:59], v18 offset:0
  ds_read_b128 v[60:63], v18 offset:4096
  v_mfma_f32_32x32x16_bf16 v[104:119], v[24:27], v[36:39], 0
  ds_read_b64_tr_b16 v[64:65], v20 offset:8192
  ds_read_b64_tr_b16 v[66:67], v20 offset:9216
  v_mfma_f32_32x32x16_bf16 v[120:135], v[28:31], v[32:35], 0
  ds_read_b64_tr_b16 v[68:69], v21 offset:8192
  v_mfma_f32_32x32x16_bf16 v[136:151], v[28:31], v[36:39], 0
  ds_read_b64_tr_b16 v[70:71], v21 offset:9216
  s_branch gated_mix__softmax_full_mha__sliding_local_dilated__prompt_kernel_vv_in
  .p2align 6
gated_mix__softmax_full_mha__sliding_local_dilated__prompt_kernel_vv_loop:
  s_waitcnt lgkmcnt(6)
  v_mfma_f32_32x32x16_bf16 v[88:103], v[24:27], v[32:35], v[88:103]
  ds_read_b128 v[56:59], v18 offset:0
  ds_read_b128 v[60:63], v18 offset:4096
  v_mfma_f32_32x32x16_bf16 v[104:119], v[24:27], v[36:39], v[104:119]
  ds_read_b64_tr_b16 v[64:65], v20 offset:8192
  ds_read_b64_tr_b16 v[66:67], v20 offset:9216
  v_mfma_f32_32x32x16_bf16 v[120:135], v[28:31], v[32:35], v[120:135]
  ds_read_b64_tr_b16 v[68:69], v21 offset:8192
  v_mfma_f32_32x32x16_bf16 v[136:151], v[28:31], v[36:39], v[136:151]
  ds_read_b64_tr_b16 v[70:71], v21 offset:9216
gated_mix__softmax_full_mha__sliding_local_dilated__prompt_kernel_vv_in:
  s_waitcnt lgkmcnt(6)
  v_mfma_f32_32x32x16_bf16 v[88:103], v[40:43], v[48:51], v[88:103]
  ds_read_b128 v[72:75], v19 offset:0
  ds_read_b128 v[76:79], v19 offset:4096
  v_mfma_f32_32x32x16_bf16 v[104:119], v[40:43], v[52:55], v[104:119]
  ds_read_b64_tr_b16 v[80:81], v20 offset:12288
  ds_read_b64_tr_b16 v[82:83], v20 offset:13312
  v_mfma_f32_32x32x16_bf16 v[120:135], v[44:47], v[48:51], v[120:135]
  ds_read_b64_tr_b16 v[84:85], v21 offset:12288
  v_mfma_f32_32x32x16_bf16 v[136:151], v[44:47], v[52:55], v[136:151]
  ds_read_b64_tr_b16 v[86:87], v21 offset:13312
  s_waitcnt lgkmcnt(6)
  v_mfma_f32_32x32x16_bf16 v[88:103], v[56:59], v[64:67], v[88:103]
  v_mfma_f32_32x32x16_bf16 v[104:119], v[56:59], v[68:71], v[104:119]
  v_mfma_f32_32x32x16_bf16 v[120:135], v[60:63], v[64:67], v[120:135]
  v_mfma_f32_32x32x16_bf16 v[136:151], v[60:63], v[68:71], v[136:151]
  s_waitcnt lgkmcnt(0)
  s_barrier
  v_mfma_f32_32x32x16_bf16 v[88:103], v[72:75], v[80:83], v[88:103]
  ds_read_b128 v[24:27], v16 offset:32768
  ds_read_b128 v[28:31], v16 offset:36864
  ds_read_b64_tr_b16 v[32:33], v20 offset:32768
  v_mfma_f32_32x32x16_bf16 v[104:119], v[72:75], v[84:87], v[104:119]
  ds_read_b64_tr_b16 v[34:35], v20 offset:33792
  ds_read_b64_tr_b16 v[36:37], v21 offset:32768
  ds_read_b64_tr_b16 v[38:39], v21 offset:33792
  v_mfma_f32_32x32x16_bf16 v[120:135], v[76:79], v[80:83], v[120:135]
  ds_read_b128 v[40:43], v17 offset:32768
  ds_read_b128 v[44:47], v17 offset:36864
  ds_read_b64_tr_b16 v[48:49], v20 offset:36864
  v_mfma_f32_32x32x16_bf16 v[136:151], v[76:79], v[84:87], v[136:151]
  ds_read_b64_tr_b16 v[50:51], v20 offset:37888
  ds_read_b64_tr_b16 v[52:53], v21 offset:36864
  ds_read_b64_tr_b16 v[54:55], v21 offset:37888
  s_waitcnt lgkmcnt(6)
  v_mfma_f32_32x32x16_bf16 v[88:103], v[24:27], v[32:35], v[88:103]
  ds_read_b128 v[56:59], v18 offset:32768
  ds_read_b128 v[60:63], v18 offset:36864
  v_mfma_f32_32x32x16_bf16 v[104:119], v[24:27], v[36:39], v[104:119]
  ds_read_b64_tr_b16 v[64:65], v20 offset:40960
  ds_read_b64_tr_b16 v[66:67], v20 offset:41984
  v_mfma_f32_32x32x16_bf16 v[120:135], v[28:31], v[32:35], v[120:135]
  ds_read_b64_tr_b16 v[68:69], v21 offset:40960
  v_mfma_f32_32x32x16_bf16 v[136:151], v[28:31], v[36:39], v[136:151]
  ds_read_b64_tr_b16 v[70:71], v21 offset:41984
  s_waitcnt lgkmcnt(6)
  v_mfma_f32_32x32x16_bf16 v[88:103], v[40:43], v[48:51], v[88:103]
  ds_read_b128 v[72:75], v19 offset:32768
  ds_read_b128 v[76:79], v19 offset:36864
  v_mfma_f32_32x32x16_bf16 v[104:119], v[40:43], v[52:55], v[104:119]
  ds_read_b64_tr_b16 v[80:81], v20 offset:45056
  ds_read_b64_tr_b16 v[82:83], v20 offset:46080
  v_mfma_f32_32x32x16_bf16 v[120:135], v[44:47], v[48:51], v[120:135]
  ds_read_b64_tr_b16 v[84:85], v21 offset:45056
  v_mfma_f32_32x32x16_bf16 v[136:151], v[44:47], v[52:55], v[136:151]
  ds_read_b64_tr_b16 v[86:87], v21 offset:46080
  s_waitcnt lgkmcnt(6)
  v_mfma_f32_32x32x16_bf16 v[88:103], v[56:59], v[64:67], v[88:103]
  v_mfma_f32_32x32x16_bf16 v[104:119], v[56:59], v[68:71], v[104:119]
  v_mfma_f32_32x32x16_bf16 v[120:135], v[60:63], v[64:67], v[120:135]
  v_mfma_f32_32x32x16_bf16 v[136:151], v[60:63], v[68:71], v[136:151]
  s_waitcnt lgkmcnt(0)
  s_barrier
  v_xor_b32 v16, 65536, v16
  v_xor_b32 v17, 65536, v17
  v_xor_b32 v18, 65536, v18
  v_xor_b32 v19, 65536, v19
  v_xor_b32 v20, 65536, v20
  v_xor_b32 v21, 65536, v21
  v_mfma_f32_32x32x16_bf16 v[88:103], v[72:75], v[80:83], v[88:103]
  ds_read_b128 v[24:27], v16 offset:0
  ds_read_b128 v[28:31], v16 offset:4096
  ds_read_b64_tr_b16 v[32:33], v20 offset:0
  v_mfma_f32_32x32x16_bf16 v[104:119], v[72:75], v[84:87], v[104:119]
  ds_read_b64_tr_b16 v[34:35], v20 offset:1024
  ds_read_b64_tr_b16 v[36:37], v21 offset:0
  ds_read_b64_tr_b16 v[38:39], v21 offset:1024
  v_mfma_f32_32x32x16_bf16 v[120:135], v[76:79], v[80:83], v[120:135]
  ds_read_b128 v[40:43], v17 offset:0
  ds_read_b128 v[44:47], v17 offset:4096
  ds_read_b64_tr_b16 v[48:49], v20 offset:4096
  v_mfma_f32_32x32x16_bf16 v[136:151], v[76:79], v[84:87], v[136:151]
  ds_read_b64_tr_b16 v[50:51], v20 offset:5120
  ds_read_b64_tr_b16 v[52:53], v21 offset:4096
  ds_read_b64_tr_b16 v[54:55], v21 offset:5120
  s_lshl_b32 s90, s3, 3
  s_add_u32 s90, s90, s40
  s_cmp_eq_u32 s90, 8
  s_cbranch_scc1 gated_mix__softmax_full_mha__sliding_local_dilated__prompt_kernel_vv_pub
  s_cmp_eq_u32 s90, 1
  s_cbranch_scc1 gated_mix__softmax_full_mha__sliding_local_dilated__prompt_kernel_vv_tb
gated_mix__softmax_full_mha__sliding_local_dilated__prompt_kernel_vv_pub_back:
  s_add_u32 s40, s40, 1
  s_cmp_lt_u32 s40, 5
  s_cbranch_scc1 gated_mix__softmax_full_mha__sliding_local_dilated__prompt_kernel_vv_loop
  s_cmp_eq_u32 s3, 1
  s_cbranch_scc1 gated_mix__softmax_full_mha__sliding_local_dilated__prompt_kernel_vv_last
  v_mov_b32 v13, 0
  global_load_dword v12, v13, s[100:101] sc1
  s_nop 7
  s_nop 3
  v_cmp_eq_u32 s[50:51], 19, v242
  v_cmp_eq_u32 s[52:53], 19, v243
  v_cvt_pk_bf16_f32 v198, v88, v89
  v_cvt_pk_bf16_f32 v199, v90, v91
  v_cvt_pk_bf16_f32 v200, v92, v93
  v_cvt_pk_bf16_f32 v201, v94, v95
  v_cvt_pk_bf16_f32 v202, v96, v97
  v_cvt_pk_bf16_f32 v203, v98, v99
  v_cvt_pk_bf16_f32 v204, v100, v101
  v_cvt_pk_bf16_f32 v205, v102, v103
  buffer_store_dwordx4 v[198:201], v240, s[16:19], s68 offen offset:0 sc1
  buffer_store_dwordx4 v[202:205], v240, s[16:19], s68 offen offset:768 sc1
  v_cvt_pk_bf16_f32 v208, v104, v105
  v_cvt_pk_bf16_f32 v209, v106, v107
  v_cvt_pk_bf16_f32 v210, v108, v109
  v_cvt_pk_bf16_f32 v211, v110, v111
  v_cvt_pk_bf16_f32 v212, v112, v113
  v_cvt_pk_bf16_f32 v213, v114, v115
  v_cvt_pk_bf16_f32 v214, v116, v117
  v_cvt_pk_bf16_f32 v215, v118, v119
  buffer_store_dwordx4 v[208:211], v241, s[16:19], s68 offen offset:0 sc1
  buffer_store_dwordx4 v[212:215], v241, s[16:19], s68 offen offset:768 sc1
  s_add_u32 s68, s68, s67
  v_cvt_pk_bf16_f32 v198, v120, v121
  v_cvt_pk_bf16_f32 v199, v122, v123
  v_cvt_pk_bf16_f32 v200, v124, v125
  v_cvt_pk_bf16_f32 v201, v126, v127
  v_cvt_pk_bf16_f32 v202, v128, v129
  v_cvt_pk_bf16_f32 v203, v130, v131
  v_cvt_pk_bf16_f32 v204, v132, v133
  v_cvt_pk_bf16_f32 v205, v134, v135
  buffer_store_dwordx4 v[198:201], v240, s[16:19], s68 offen offset:0 sc1
  buffer_store_dwordx4 v[202:205], v240, s[16:19], s68 offen offset:768 sc1
  v_cvt_pk_bf16_f32 v208, v136, v137
  v_cvt_pk_bf16_f32 v209, v138, v139
  v_cvt_pk_bf16_f32 v210, v140, v141
  v_cvt_pk_bf16_f32 v211, v142, v143
  v_cvt_pk_bf16_f32 v212, v144, v145
  v_cvt_pk_bf16_f32 v213, v146, v147
  v_cvt_pk_bf16_f32 v214, v148, v149
  v_cvt_pk_bf16_f32 v215, v150, v151
  buffer_store_dwordx4 v[208:211], v241, s[16:19], s68 offen offset:0 sc1
  buffer_store_dwordx4 v[212:215], v241, s[16:19], s68 offen offset:768 sc1
  s_mov_b32 s3, 1
  s_branch gated_mix__softmax_full_mha__sliding_local_dilated__prompt_kernel_vv_prob
gated_mix__softmax_full_mha__sliding_local_dilated__prompt_kernel_vv_pub:
  s_waitcnt vmcnt(0)
  s_mov_b32 s90, 200000
  v_readfirstlane_b32 s66, v12
  s_nop 3
  s_cmp_lg_u32 s66, 0
  s_cbranch_scc1 gated_mix__softmax_full_mha__sliding_local_dilated__prompt_kernel_n1vv_ok
  v_mov_b32 v13, 0
gated_mix__softmax_full_mha__sliding_local_dilated__prompt_kernel_n1vv:
  global_load_dword v12, v13, s[100:101] sc1
  s_waitcnt vmcnt(0)
  v_readfirstlane_b32 s66, v12
  s_nop 3
  s_cmp_lg_u32 s66, 0
  s_cbranch_scc1 gated_mix__softmax_full_mha__sliding_local_dilated__prompt_kernel_n1vv_ok
  s_sub_u32 s90, s90, 1
  s_cmp_eq_u32 s90, 0
  s_cbranch_scc1 gated_mix__softmax_full_mha__sliding_local_dilated__prompt_kernel_n1vv_ok
  s_sleep 1
  s_branch gated_mix__softmax_full_mha__sliding_local_dilated__prompt_kernel_n1vv
gated_mix__softmax_full_mha__sliding_local_dilated__prompt_kernel_n1vv_ok:
  s_mov_b64 exec, 1
  v_mov_b32 v8, 147456
  v_mov_b32 v9, 1
  ds_add_rtn_u32 v10, v8, v9
  s_waitcnt lgkmcnt(0)
  s_mov_b64 exec, -1
  v_readfirstlane_b32 s91, v10
  s_nop 3
  s_cmp_lg_u32 s91, 3
  s_cbranch_scc1 gated_mix__softmax_full_mha__sliding_local_dilated__prompt_kernel_vv_nopub
  s_lshl_b32 s91, s2, 2
  s_add_u32 s91, s91, 26214400
  v_lshlrev_b32 v9, 10, v2
  v_mov_b32 v8, s66
  s_mov_b32 exec_hi, 0
  buffer_store_dword v8, v9, s[16:19], s91 offen sc1
  s_mov_b64 exec, -1
gated_mix__softmax_full_mha__sliding_local_dilated__prompt_kernel_vv_nopub:
  s_branch gated_mix__softmax_full_mha__sliding_local_dilated__prompt_kernel_vv_pub_back
gated_mix__softmax_full_mha__sliding_local_dilated__prompt_kernel_vv_tb:
  s_lshr_b32 s90, s2, 3
  s_lshl_b32 s90, s90, 2
  s_add_u32 s90, s90, s20
  s_lshl_b32 s91, s90, 6
  v_add_u32 v246, s91, v2
  s_and_b32 s91, s2, 1
  s_lshl_b32 s91, s91, 11
  v_lshrrev_b32 v247, 4, v246
  v_and_b32 v248, 15, v246
  v_lshlrev_b32 v248, 7, v248
  v_add_u32 v248, s91, v248
  v_mul_u32_u24 v247, 3840, v247
  v_add_u32 v247, v247, v248
  s_mul_i32 s91, s90, 80
  v_add_u32 v246, s91, v2
  s_and_b32 s91, s2, 1
  s_lshl_b32 s91, s91, 11
  s_mov_b32 exec_hi, 0xff
  v_lshrrev_b32 v247, 4, v246
  v_and_b32 v248, 15, v246
  v_lshlrev_b32 v248, 7, v248
  v_mul_u32_u24 v247, 3840, v247
  v_add_u32 v247, v247, v248
  buffer_load_dword v249, v247, s[12:15], s91 offen
  v_add_u32 v246, 40, v246
  v_lshrrev_b32 v247, 4, v246
  v_and_b32 v248, 15, v246
  v_lshlrev_b32 v248, 7, v248
  v_mul_u32_u24 v247, 3840, v247
  v_add_u32 v247, v247, v248
  buffer_load_dword v250, v247, s[12:15], s91 offen
  s_mov_b64 exec, -1
  s_branch gated_mix__softmax_full_mha__sliding_local_dilated__prompt_kernel_vv_pub_back
gated_mix__softmax_full_mha__sliding_local_dilated__prompt_kernel_vv_last:
  s_waitcnt lgkmcnt(0)
  s_lshl_b32 s8, s22, 2
  s_lshl_b32 s9, s24, 1
  s_add_u32 s8, s8, s9
  s_mul_i32 s8, s8, 2560
  s_mul_i32 s9, s21, 163840
  s_add_u32 s8, s8, s9
  s_add_u32 s8, s8, 0
  s_add_u32 s9, s8, 2560
  buffer_load_dwordx4 v[16:19], v244, s[16:19], s8 offen sc1
  buffer_load_dwordx2 v[24:25], v245, s[16:19], s8 offen sc1
  buffer_load_dwordx4 v[20:23], v244, s[16:19], s9 offen sc1
  buffer_load_dwordx2 v[26:27], v245, s[16:19], s9 offen sc1
  s_nop 7
  v_cmp_eq_u32 s[50:51], 19, v242
  v_cmp_eq_u32 s[52:53], 19, v243
  v_cvt_pk_bf16_f32 v198, v88, v89
  v_cvt_pk_bf16_f32 v199, v90, v91
  v_cvt_pk_bf16_f32 v200, v92, v93
  v_cvt_pk_bf16_f32 v201, v94, v95
  v_cvt_pk_bf16_f32 v202, v96, v97
  v_cvt_pk_bf16_f32 v203, v98, v99
  v_cvt_pk_bf16_f32 v204, v100, v101
  v_cvt_pk_bf16_f32 v205, v102, v103
  buffer_store_dwordx4 v[198:201], v240, s[16:19], s69 offen offset:0 sc1
  buffer_store_dwordx4 v[202:205], v240, s[16:19], s69 offen offset:768 sc1
  v_cvt_pk_bf16_f32 v208, v104, v105
  v_cvt_pk_bf16_f32 v209, v106, v107
  v_cvt_pk_bf16_f32 v210, v108, v109
  v_cvt_pk_bf16_f32 v211, v110, v111
  v_cvt_pk_bf16_f32 v212, v112, v113
  v_cvt_pk_bf16_f32 v213, v114, v115
  v_cvt_pk_bf16_f32 v214, v116, v117
  v_cvt_pk_bf16_f32 v215, v118, v119
  buffer_store_dwordx4 v[208:211], v241, s[16:19], s69 offen offset:0 sc1
  buffer_store_dwordx4 v[212:215], v241, s[16:19], s69 offen offset:768 sc1
  s_add_u32 s69, s69, s67
  v_cvt_pk_bf16_f32 v198, v120, v121
  v_cvt_pk_bf16_f32 v199, v122, v123
  v_cvt_pk_bf16_f32 v200, v124, v125
  v_cvt_pk_bf16_f32 v201, v126, v127
  v_cvt_pk_bf16_f32 v202, v128, v129
  v_cvt_pk_bf16_f32 v203, v130, v131
  v_cvt_pk_bf16_f32 v204, v132, v133
  v_cvt_pk_bf16_f32 v205, v134, v135
  buffer_store_dwordx4 v[198:201], v240, s[16:19], s69 offen offset:0 sc1
  buffer_store_dwordx4 v[202:205], v240, s[16:19], s69 offen offset:768 sc1
  v_cvt_pk_bf16_f32 v208, v136, v137
  v_cvt_pk_bf16_f32 v209, v138, v139
  v_cvt_pk_bf16_f32 v210, v140, v141
  v_cvt_pk_bf16_f32 v211, v142, v143
  v_cvt_pk_bf16_f32 v212, v144, v145
  v_cvt_pk_bf16_f32 v213, v146, v147
  v_cvt_pk_bf16_f32 v214, v148, v149
  v_cvt_pk_bf16_f32 v215, v150, v151
  buffer_store_dwordx4 v[208:211], v241, s[16:19], s69 offen offset:0 sc1
  buffer_store_dwordx4 v[212:215], v241, s[16:19], s69 offen offset:768 sc1
  s_branch gated_mix__softmax_full_mha__sliding_local_dilated__prompt_kernel_cdone
gated_mix__softmax_full_mha__sliding_local_dilated__prompt_kernel_cdone:
  s_mov_b32 s3, 1
  s_waitcnt vmcnt(8)
  s_branch gated_mix__softmax_full_mha__sliding_local_dilated__prompt_kernel_attn
gated_mix__softmax_full_mha__sliding_local_dilated__prompt_kernel_loader:
  s_sub_u32 s24, s20, 4
  s_lshl_b32 s25, s22, 7
  s_lshl_b32 s26, s24, 5
  v_lshrrev_b32 v3, 3, v2
  v_lshrrev_b32 v4, 4, v2
  v_and_b32 v5, 7, v2
  s_movk_i32 s33, 1280
  s_lshl_b32 s27, s24, 4
  v_add_u32 v6, s27, v4
  s_movk_i32 s34, 3840
  s_lshl_b32 s35, s23, 8
  v_and_b32 v7, 15, v2
  v_lshlrev_b32 v8, 2, v4
  v_xor_b32 v7, v7, v8
  v_lshlrev_b32 v7, 4, v7
  v_add_u32 v7, s35, v7
  v_mad_u32_u24 v24, v6, s34, v7
  s_lshl_b32 s84, s24, 12
  s_add_u32 s85, s84, 16384
  v_add_u32 v6, s26, v3
  v_add_u32 v8, 0, v4
  v_and_b32 v8, 7, v8
  v_xor_b32 v8, v5, v8
  v_lshlrev_b32 v8, 4, v8
  v_add_u32 v7, s25, v6
  v_mad_u32_u24 v16, v7, s33, v8
  v_and_b32 v7, 63, v6
  v_lshlrev_b32 v7, 1, v7
  v_lshrrev_b32 v9, 6, v6
  v_add3_u32 v7, v7, v9, s25
  v_mad_u32_u24 v20, v7, s33, v8
  v_add_u32 v6, s26, v3
  v_add_u32 v6, 8, v6
  v_add_u32 v8, 4, v4
  v_and_b32 v8, 7, v8
  v_xor_b32 v8, v5, v8
  v_lshlrev_b32 v8, 4, v8
  v_add_u32 v7, s25, v6
  v_mad_u32_u24 v17, v7, s33, v8
  v_and_b32 v7, 63, v6
  v_lshlrev_b32 v7, 1, v7
  v_lshrrev_b32 v9, 6, v6
  v_add3_u32 v7, v7, v9, s25
  v_mad_u32_u24 v21, v7, s33, v8
  v_add_u32 v6, s26, v3
  v_add_u32 v6, 16, v6
  v_add_u32 v8, 8, v4
  v_and_b32 v8, 7, v8
  v_xor_b32 v8, v5, v8
  v_lshlrev_b32 v8, 4, v8
  v_add_u32 v7, s25, v6
  v_mad_u32_u24 v18, v7, s33, v8
  v_and_b32 v7, 63, v6
  v_lshlrev_b32 v7, 1, v7
  v_lshrrev_b32 v9, 6, v6
  v_add3_u32 v7, v7, v9, s25
  v_mad_u32_u24 v22, v7, s33, v8
  v_add_u32 v6, s26, v3
  v_add_u32 v6, 24, v6
  v_add_u32 v8, 12, v4
  v_and_b32 v8, 7, v8
  v_xor_b32 v8, v5, v8
  v_lshlrev_b32 v8, 4, v8
  v_add_u32 v7, s25, v6
  v_mad_u32_u24 v19, v7, s33, v8
  v_and_b32 v7, 63, v6
  v_lshlrev_b32 v7, 1, v7
  v_lshrrev_b32 v9, 6, v6
  v_add3_u32 v7, v7, v9, s25
  v_mad_u32_u24 v23, v7, s33, v8
  s_mov_b32 s70, 0
  s_mov_b32 s71, 0
  s_waitcnt lgkmcnt(0)
  s_mov_b64 s[72:73], s[4:5]
  s_mov_b32 s74, 2621440
  s_mov_b32 s75, 0x20000
  s_mov_b64 s[76:77], s[6:7]
  s_mov_b32 s78, 2457600
  s_mov_b32 s79, 0x20000
  s_mov_b64 s[80:81], s[30:31]
  s_mov_b32 s82, 2457600
  s_mov_b32 s83, 0x20000
  s_mov_b32 s16, s36
  s_mov_b32 s17, s37
  s_mov_b32 s18, 268435456
  s_mov_b32 s19, 0x20000
  s_lshl_b32 s86, s70, 7
  s_add_u32 s87, s84, s71
  s_add_u32 m0, s87, 0
  s_nop 0
  buffer_load_dwordx4 v16, s[72:75], s86 offen lds
  s_add_u32 m0, s87, 1024
  s_nop 0
  buffer_load_dwordx4 v17, s[72:75], s86 offen lds
  s_add_u32 m0, s87, 2048
  s_nop 0
  buffer_load_dwordx4 v18, s[72:75], s86 offen lds
  s_add_u32 m0, s87, 3072
  s_nop 0
  buffer_load_dwordx4 v19, s[72:75], s86 offen lds
  s_mul_i32 s86, s70, 245760
  s_add_u32 s87, s85, s71
  s_add_u32 m0, s87, 0
  s_nop 0
  buffer_load_dwordx4 v24, s[76:79], s86 offen lds
  s_add_u32 s86, s86, 15360
  s_add_u32 m0, s87, 1024
  s_nop 0
  buffer_load_dwordx4 v24, s[76:79], s86 offen lds
  s_add_u32 s86, s86, 15360
  s_add_u32 m0, s87, 2048
  s_nop 0
  buffer_load_dwordx4 v24, s[76:79], s86 offen lds
  s_add_u32 s86, s86, 15360
  s_add_u32 m0, s87, 3072
  s_nop 0
  buffer_load_dwordx4 v24, s[76:79], s86 offen lds
  s_add_u32 s70, s70, 1
  s_add_u32 s71, s71, 32768
  s_and_b32 s71, s71, 131071
  s_lshl_b32 s86, s70, 7
  s_add_u32 s87, s84, s71
  s_add_u32 m0, s87, 0
  s_nop 0
  buffer_load_dwordx4 v16, s[72:75], s86 offen lds
  s_add_u32 m0, s87, 1024
  s_nop 0
  buffer_load_dwordx4 v17, s[72:75], s86 offen lds
  s_add_u32 m0, s87, 2048
  s_nop 0
  buffer_load_dwordx4 v18, s[72:75], s86 offen lds
  s_add_u32 m0, s87, 3072
  s_nop 0
  buffer_load_dwordx4 v19, s[72:75], s86 offen lds
  s_mul_i32 s86, s70, 245760
  s_add_u32 s87, s85, s71
  s_add_u32 m0, s87, 0
  s_nop 0
  buffer_load_dwordx4 v24, s[76:79], s86 offen lds
  s_add_u32 s86, s86, 15360
  s_add_u32 m0, s87, 1024
  s_nop 0
  buffer_load_dwordx4 v24, s[76:79], s86 offen lds
  s_add_u32 s86, s86, 15360
  s_add_u32 m0, s87, 2048
  s_nop 0
  buffer_load_dwordx4 v24, s[76:79], s86 offen lds
  s_add_u32 s86, s86, 15360
  s_add_u32 m0, s87, 3072
  s_nop 0
  buffer_load_dwordx4 v24, s[76:79], s86 offen lds
  s_add_u32 s70, s70, 1
  s_add_u32 s71, s71, 32768
  s_and_b32 s71, s71, 131071
  s_waitcnt vmcnt(8)
  s_barrier
  s_lshl_b32 s86, s70, 7
  s_add_u32 s87, s84, s71
  s_add_u32 m0, s87, 0
  s_nop 0
  buffer_load_dwordx4 v16, s[72:75], s86 offen lds
  s_add_u32 m0, s87, 1024
  s_nop 0
  buffer_load_dwordx4 v17, s[72:75], s86 offen lds
  s_add_u32 m0, s87, 2048
  s_nop 0
  buffer_load_dwordx4 v18, s[72:75], s86 offen lds
  s_add_u32 m0, s87, 3072
  s_nop 0
  buffer_load_dwordx4 v19, s[72:75], s86 offen lds
  s_mul_i32 s86, s70, 245760
  s_add_u32 s87, s85, s71
  s_add_u32 m0, s87, 0
  s_nop 0
  buffer_load_dwordx4 v24, s[76:79], s86 offen lds
  s_add_u32 s86, s86, 15360
  s_add_u32 m0, s87, 1024
  s_nop 0
  buffer_load_dwordx4 v24, s[76:79], s86 offen lds
  s_add_u32 s86, s86, 15360
  s_add_u32 m0, s87, 2048
  s_nop 0
  buffer_load_dwordx4 v24, s[76:79], s86 offen lds
  s_add_u32 s86, s86, 15360
  s_add_u32 m0, s87, 3072
  s_nop 0
  buffer_load_dwordx4 v24, s[76:79], s86 offen lds
  s_add_u32 s70, s70, 1
  s_add_u32 s71, s71, 32768
  s_and_b32 s71, s71, 131071
  s_lshl_b32 s86, s70, 7
  s_add_u32 s87, s84, s71
  s_add_u32 m0, s87, 0
  s_nop 0
  buffer_load_dwordx4 v16, s[72:75], s86 offen lds
  s_add_u32 m0, s87, 1024
  s_nop 0
  buffer_load_dwordx4 v17, s[72:75], s86 offen lds
  s_add_u32 m0, s87, 2048
  s_nop 0
  buffer_load_dwordx4 v18, s[72:75], s86 offen lds
  s_add_u32 m0, s87, 3072
  s_nop 0
  buffer_load_dwordx4 v19, s[72:75], s86 offen lds
  s_mul_i32 s86, s70, 245760
  s_add_u32 s87, s85, s71
  s_add_u32 m0, s87, 0
  s_nop 0
  buffer_load_dwordx4 v24, s[76:79], s86 offen lds
  s_add_u32 s86, s86, 15360
  s_add_u32 m0, s87, 1024
  s_nop 0
  buffer_load_dwordx4 v24, s[76:79], s86 offen lds
  s_add_u32 s86, s86, 15360
  s_add_u32 m0, s87, 2048
  s_nop 0
  buffer_load_dwordx4 v24, s[76:79], s86 offen lds
  s_add_u32 s86, s86, 15360
  s_add_u32 m0, s87, 3072
  s_nop 0
  buffer_load_dwordx4 v24, s[76:79], s86 offen lds
  s_add_u32 s70, s70, 1
  s_add_u32 s71, s71, 32768
  s_and_b32 s71, s71, 131071
  s_waitcnt vmcnt(16)
  s_barrier
  s_lshl_b32 s86, s70, 7
  s_add_u32 s87, s84, s71
  s_add_u32 m0, s87, 0
  s_nop 0
  buffer_load_dwordx4 v16, s[72:75], s86 offen lds
  s_add_u32 m0, s87, 1024
  s_nop 0
  buffer_load_dwordx4 v17, s[72:75], s86 offen lds
  s_add_u32 m0, s87, 2048
  s_nop 0
  buffer_load_dwordx4 v18, s[72:75], s86 offen lds
  s_add_u32 m0, s87, 3072
  s_nop 0
  buffer_load_dwordx4 v19, s[72:75], s86 offen lds
  s_mul_i32 s86, s70, 245760
  s_add_u32 s87, s85, s71
  s_add_u32 m0, s87, 0
  s_nop 0
  buffer_load_dwordx4 v24, s[76:79], s86 offen lds
  s_add_u32 s86, s86, 15360
  s_add_u32 m0, s87, 1024
  s_nop 0
  buffer_load_dwordx4 v24, s[76:79], s86 offen lds
  s_add_u32 s86, s86, 15360
  s_add_u32 m0, s87, 2048
  s_nop 0
  buffer_load_dwordx4 v24, s[76:79], s86 offen lds
  s_add_u32 s86, s86, 15360
  s_add_u32 m0, s87, 3072
  s_nop 0
  buffer_load_dwordx4 v24, s[76:79], s86 offen lds
  s_add_u32 s70, s70, 1
  s_add_u32 s71, s71, 32768
  s_and_b32 s71, s71, 131071
  s_and_b32 s8, s2, 7
  s_lshr_b32 s9, s2, 3
  s_and_b32 s10, s9, 1
  s_lshl_b32 s8, s8, 1
  s_add_u32 s21, s8, s10
  s_lshr_b32 s22, s9, 1
  s_and_b32 s23, s20, 1
  s_bfe_u32 s24, s20, 0x10001
  s_lshr_b32 s25, s20, 2
  s_mov_b32 s32, -1
  s_mov_b32 s33, 0
  s_cmp_eq_u32 s23, 0
  s_cselect_b32 s34, -1, 0
  s_cselect_b32 s35, 0, -1
  v_and_b32 v8, 31, v2
  v_lshrrev_b32 v9, 5, v2
  s_mul_i32 s10, s21, 360448
  s_add_u32 s26, s10, 6291456
  s_mul_i32 s9, s23, 1536
  v_lshlrev_b32 v10, 4, v8
  v_lshlrev_b32 v11, 9, v9
  v_add3_u32 v244, v10, v11, s9
  v_lshlrev_b32 v12, 3, v9
  v_add_u32 v12, v10, v12
  v_add_u32 v245, 1024, v12
  s_mul_i32 s9, s23, 1536
  v_mul_u32_u24 v11, 384, v9
  v_min_u32 v13, 21, v8
  v_lshlrev_b32 v13, 4, v13
  v_add3_u32 v13, v13, v11, s9
  v_add_u32 v0, 2560, v13
  s_mul_i32 s9, s25, 22528
  v_add_u32 v3, s9, v244
  v_add_u32 v4, s9, v245
  v_add_u32 v5, s9, v0
  s_lshl_b32 s28, s20, 10
  v_lshlrev_b32 v12, 4, v2
  v_add_u32 v6, s28, v12
  s_lshl_b32 s9, s20, 9
  s_add_u32 s38, s9, 40960
  v_add_u32 v7, s38, v12
  s_lshl_b32 s8, s22, 2
  s_lshl_b32 s9, s24, 1
  s_add_u32 s8, s8, s9
  s_add_u32 s39, s8, s25
  s_mul_i32 s8, s39, 2560
  s_mul_i32 s9, s21, 163840
  s_add_u32 s8, s8, s9
  s_add_u32 s8, s8, 18874368
  s_lshl_b32 s9, s23, 10
  s_add_u32 s9, s9, s8
  v_lshlrev_b32 v11, 9, v9
  v_add3_u32 v14, v10, v11, s9
  s_lshl_b32 s9, s23, 8
  s_add_u32 s9, s9, s8
  s_add_u32 s9, s9, 2048
  v_lshrrev_b32 v11, 1, v10
  v_add_u32 v1, s9, v11
  s_mul_i32 s8, s20, 3328
  s_add_u32 s8, s8, 0
  v_add_u32 v15, s8, v12
  s_lshl_b32 s8, s39, 5
  v_add_u32 v10, s8, v8
  v_lshlrev_b32 v10, 2, v10
  v_add_u32 v216, 25165824, v10
  s_lshl_b32 s8, s22, 7
  s_lshl_b32 s9, s25, 6
  s_add_u32 s8, s8, s9
  s_add_u32 s8, s8, s24
  v_lshlrev_b32 v10, 1, v8
  v_add_u32 v10, s8, v10
  v_lshlrev_b32 v10, 2, v10
  v_add_u32 v227, 25165824, v10
  v_cndmask_b32 v228, 0, -1, s[34:35]
  v_lshlrev_b32 v10, 2, v9
  v_sub_u32 v10, v8, v10
  v_mov_b32 v13, 0xf149f2ca
  v_subrev_u32 v11, 0, v10
  v_cmp_gt_u32 s[50:51], 8, v11
  v_subrev_u32 v12, 1, v10
  v_cmp_gt_u32 s[52:53], 8, v12
  v_subrev_u32 v11, 2, v10
  v_cmp_gt_u32 s[54:55], 8, v11
  v_subrev_u32 v12, 3, v10
  v_cmp_gt_u32 s[56:57], 8, v12
  v_cndmask_b32 v166, v13, 0, s[50:51]
  v_cndmask_b32 v167, v13, 0, s[52:53]
  v_cndmask_b32 v168, v13, 0, s[54:55]
  v_cndmask_b32 v169, v13, 0, s[56:57]
  v_subrev_u32 v11, 8, v10
  v_cmp_gt_u32 s[50:51], 8, v11
  v_subrev_u32 v12, 9, v10
  v_cmp_gt_u32 s[52:53], 8, v12
  v_subrev_u32 v11, 10, v10
  v_cmp_gt_u32 s[54:55], 8, v11
  v_subrev_u32 v12, 11, v10
  v_cmp_gt_u32 s[56:57], 8, v12
  v_cndmask_b32 v170, v13, 0, s[50:51]
  v_cndmask_b32 v171, v13, 0, s[52:53]
  v_cndmask_b32 v172, v13, 0, s[54:55]
  v_cndmask_b32 v173, v13, 0, s[56:57]
  v_subrev_u32 v11, 16, v10
  v_cmp_gt_u32 s[50:51], 8, v11
  v_subrev_u32 v12, 17, v10
  v_cmp_gt_u32 s[52:53], 8, v12
  v_subrev_u32 v11, 18, v10
  v_cmp_gt_u32 s[54:55], 8, v11
  v_subrev_u32 v12, 19, v10
  v_cmp_gt_u32 s[56:57], 8, v12
  v_cndmask_b32 v174, v13, 0, s[50:51]
  v_cndmask_b32 v175, v13, 0, s[52:53]
  v_cndmask_b32 v176, v13, 0, s[54:55]
  v_cndmask_b32 v177, v13, 0, s[56:57]
  v_subrev_u32 v11, 24, v10
  v_cmp_gt_u32 s[50:51], 8, v11
  v_subrev_u32 v12, 25, v10
  v_cmp_gt_u32 s[52:53], 8, v12
  v_subrev_u32 v11, 26, v10
  v_cmp_gt_u32 s[54:55], 8, v11
  v_subrev_u32 v12, 27, v10
  v_cmp_gt_u32 s[56:57], 8, v12
  v_cndmask_b32 v178, v13, 0, s[50:51]
  v_cndmask_b32 v179, v13, 0, s[52:53]
  v_cndmask_b32 v180, v13, 0, s[54:55]
  v_cndmask_b32 v181, v13, 0, s[56:57]
  s_cmp_eq_u32 s25, 1
  s_cselect_b32 s9, 1, 3
  s_cmp_lt_u32 s39, s9
  s_cselect_b32 s9, 1000, 0
  v_add_u32 v11, s9, v10
  v_cmp_gt_i32 s[50:51], 0, v11
  v_cmp_gt_i32 s[52:53], 1, v11
  v_cmp_gt_i32 s[54:55], 2, v11
  v_cmp_gt_i32 s[56:57], 3, v11
  v_cndmask_b32 v194, v13, 0, s[50:51]
  v_cndmask_b32 v195, v13, 0, s[52:53]
  v_cndmask_b32 v196, v13, 0, s[54:55]
  v_cndmask_b32 v197, v13, 0, s[56:57]
  v_mov_b32 v206, 0
  v_mov_b32 v207, 0
  s_waitcnt vmcnt(16)
  s_barrier
  s_lshl_b32 s86, s70, 7
  s_add_u32 s87, s84, s71
  s_add_u32 m0, s87, 0
  s_nop 0
  buffer_load_dwordx4 v16, s[72:75], s86 offen lds
  s_add_u32 m0, s87, 1024
  s_nop 0
  buffer_load_dwordx4 v17, s[72:75], s86 offen lds
  s_add_u32 m0, s87, 2048
  s_nop 0
  buffer_load_dwordx4 v18, s[72:75], s86 offen lds
  s_add_u32 m0, s87, 3072
  s_nop 0
  buffer_load_dwordx4 v19, s[72:75], s86 offen lds
  s_mul_i32 s86, s70, 245760
  s_add_u32 s87, s85, s71
  s_add_u32 m0, s87, 0
  s_nop 0
  buffer_load_dwordx4 v24, s[76:79], s86 offen lds
  s_add_u32 s86, s86, 15360
  s_add_u32 m0, s87, 1024
  s_nop 0
  buffer_load_dwordx4 v24, s[76:79], s86 offen lds
  s_add_u32 s86, s86, 15360
  s_add_u32 m0, s87, 2048
  s_nop 0
  buffer_load_dwordx4 v24, s[76:79], s86 offen lds
  s_add_u32 s86, s86, 15360
  s_add_u32 m0, s87, 3072
  s_nop 0
  buffer_load_dwordx4 v24, s[76:79], s86 offen lds
  s_add_u32 s70, s70, 1
  s_add_u32 s71, s71, 32768
  s_and_b32 s71, s71, 131071
  s_load_dwordx2 s[4:5], s[0:1], 16
  s_load_dwordx2 s[6:7], s[0:1], 40
  s_load_dwordx2 s[36:37], s[0:1], 56
  s_and_b32 s8, s2, 7
  s_lshr_b32 s9, s2, 3
  s_lshr_b32 s10, s8, 1
  s_lshl_b32 s10, s10, 3
  s_lshr_b32 s11, s9, 2
  s_add_u32 s42, s10, s11
  s_and_b32 s8, s8, 1
  s_lshl_b32 s8, s8, 2
  s_and_b32 s9, s9, 3
  s_add_u32 s43, s8, s9
  s_and_b32 s48, s20, 1
  s_lshr_b32 s49, s20, 1
  s_waitcnt lgkmcnt(0)
  s_mov_b32 s60, s4
  s_mov_b32 s61, s5
  s_mov_b32 s62, 819200
  s_mov_b32 s63, 0x20000
  s_mov_b32 s44, s6
  s_mov_b32 s45, s7
  s_mov_b32 s46, 819200
  s_mov_b32 s47, 0x20000
  s_mov_b32 s96, s36
  s_mov_b32 s97, s37
  s_mov_b32 s98, 2621440
  s_mov_b32 s99, 0x20000
  v_and_b32 v8, 31, v2
  v_lshrrev_b32 v9, 5, v2
  v_mul_u32_u24 v10, 43, v2
  v_lshrrev_b32 v10, 9, v10
  v_mul_u32_u24 v11, 12, v10
  v_sub_u32 v11, v2, v11
  s_mul_i32 s8, s20, 40
  v_add_u32 v12, s8, v10
  s_movk_i32 s9, 1280
  s_mul_i32 s10, s43, 160
  v_lshlrev_b32 v13, 4, v11
  v_add_u32 v13, s10, v13
  v_mad_u32_u24 v221, v12, s9, v13
  v_cmp_gt_u32 s[50:51], 10, v11
  v_cmp_gt_u32 s[52:53], 60, v2
  s_nop 3
  s_and_b64 s[58:59], s[50:51], s[52:53]
  s_mul_i32 s65, s20, 7680
  v_bfe_u32 v10, v2, 2, 2
  s_mul_i32 s8, s49, 80
  v_add_u32 v10, s8, v10
  v_bfe_u32 v11, v2, 4, 1
  v_lshlrev_b32 v11, 5, v11
  v_and_b32 v12, 3, v2
  v_lshlrev_b32 v12, 3, v12
  v_add_u32 v11, v11, v12
  v_lshlrev_b32 v12, 2, v9
  v_add_u32 v12, v10, v12
  v_mul_u32_u24 v12, 192, v12
  v_add_u32 v12, v12, v11
  v_add_u32 v217, 102400, v12
  v_add_u32 v219, 26624, v12
  v_mul_u32_u24 v12, 40, v9
  v_add3_u32 v12, v10, v12, 16
  v_mul_u32_u24 v12, 192, v12
  v_add_u32 v12, v12, v11
  v_add_u32 v218, 102400, v12
  v_add_u32 v220, 26624, v12
  s_mul_i32 s8, s49, 327680
  s_add_u32 s8, s8, 18874368
  s_lshl_b32 s9, s42, 1
  s_add_u32 s9, s9, s48
  s_mul_i32 s10, s9, 2560
  s_add_u32 s10, s10, s8
  v_lshlrev_b32 v10, 4, v8
  v_lshlrev_b32 v11, 9, v9
  v_add3_u32 v223, v10, v11, s10
  s_mov_b32 s11, 163840
  v_mul_lo_u32 v12, v9, s11
  s_add_u32 s10, s10, 2048
  v_lshrrev_b32 v13, 1, v10
  v_add3_u32 v224, v13, v12, s10
  s_lshr_b32 s10, s42, 1
  s_lshl_b32 s10, s10, 2
  s_and_b32 s13, s42, 1
  s_add_u32 s10, s10, s13
  s_mul_i32 s10, s10, 2560
  s_add_u32 s10, s10, s8
  s_lshl_b32 s13, s48, 8
  s_add_u32 s10, s10, s13
  s_add_u32 s10, s10, 2621440
  v_lshrrev_b32 v10, 1, v8
  v_and_b32 v13, 1, v8
  v_mul_u32_u24 v13, 5120, v13
  v_add_u32 v12, v12, v13
  v_add_u32 v11, v11, v13
  v_lshlrev_b32 v13, 4, v10
  v_add3_u32 v225, v13, v11, s10
  s_lshl_b32 s13, s48, 7
  s_sub_u32 s10, s10, s13
  s_add_u32 s10, s10, 2048
  v_lshlrev_b32 v13, 3, v10
  v_add3_u32 v226, v13, v12, s10
  s_lshl_b32 s10, s9, 5
  v_add_u32 v10, s10, v8
  s_mul_i32 s10, s43, 160
  s_lshl_b32 s11, s49, 4
  s_add_u32 s10, s10, s11
  v_mul_u32_u24 v10, 1280, v10
  v_add_u32 v222, s10, v10
  s_lshr_b32 s64, s42, 1
gated_mix__softmax_full_mha__sliding_local_dilated__prompt_kernel_ld1:
  s_waitcnt vmcnt(16)
  s_barrier
  s_lshl_b32 s86, s70, 7
  s_add_u32 s87, s84, s71
  s_add_u32 m0, s87, 0
  s_nop 0
  buffer_load_dwordx4 v16, s[72:75], s86 offen lds
  s_add_u32 m0, s87, 1024
  s_nop 0
  buffer_load_dwordx4 v17, s[72:75], s86 offen lds
  s_add_u32 m0, s87, 2048
  s_nop 0
  buffer_load_dwordx4 v18, s[72:75], s86 offen lds
  s_add_u32 m0, s87, 3072
  s_nop 0
  buffer_load_dwordx4 v19, s[72:75], s86 offen lds
  s_mul_i32 s86, s70, 245760
  s_add_u32 s87, s85, s71
  s_add_u32 m0, s87, 0
  s_nop 0
  buffer_load_dwordx4 v24, s[76:79], s86 offen lds
  s_add_u32 s86, s86, 15360
  s_add_u32 m0, s87, 1024
  s_nop 0
  buffer_load_dwordx4 v24, s[76:79], s86 offen lds
  s_add_u32 s86, s86, 15360
  s_add_u32 m0, s87, 2048
  s_nop 0
  buffer_load_dwordx4 v24, s[76:79], s86 offen lds
  s_add_u32 s86, s86, 15360
  s_add_u32 m0, s87, 3072
  s_nop 0
  buffer_load_dwordx4 v24, s[76:79], s86 offen lds
  s_add_u32 s70, s70, 1
  s_add_u32 s71, s71, 32768
  s_and_b32 s71, s71, 131071
  s_cmp_lt_u32 s70, 7
  s_cbranch_scc1 gated_mix__softmax_full_mha__sliding_local_dilated__prompt_kernel_ld1
gated_mix__softmax_full_mha__sliding_local_dilated__prompt_kernel_ld1b:
  s_waitcnt vmcnt(16)
  s_barrier
  s_lshl_b32 s86, s70, 7
  s_add_u32 s87, s84, s71
  s_add_u32 m0, s87, 0
  s_nop 0
  buffer_load_dwordx4 v16, s[72:75], s86 offen lds
  s_add_u32 m0, s87, 1024
  s_nop 0
  buffer_load_dwordx4 v17, s[72:75], s86 offen lds
  s_add_u32 m0, s87, 2048
  s_nop 0
  buffer_load_dwordx4 v18, s[72:75], s86 offen lds
  s_add_u32 m0, s87, 3072
  s_nop 0
  buffer_load_dwordx4 v19, s[72:75], s86 offen lds
  s_mul_i32 s86, s70, 245760
  s_add_u32 s87, s85, s71
  s_add_u32 m0, s87, 0
  s_nop 0
  buffer_load_dwordx4 v24, s[76:79], s86 offen lds
  s_add_u32 s86, s86, 15360
  s_add_u32 m0, s87, 1024
  s_nop 0
  buffer_load_dwordx4 v24, s[76:79], s86 offen lds
  s_add_u32 s86, s86, 15360
  s_add_u32 m0, s87, 2048
  s_nop 0
  buffer_load_dwordx4 v24, s[76:79], s86 offen lds
  s_add_u32 s86, s86, 15360
  s_add_u32 m0, s87, 3072
  s_nop 0
  buffer_load_dwordx4 v24, s[76:79], s86 offen lds
  s_add_u32 s70, s70, 1
  s_add_u32 s71, s71, 32768
  s_and_b32 s71, s71, 131071
  s_cmp_lt_u32 s70, 10
  s_cbranch_scc1 gated_mix__softmax_full_mha__sliding_local_dilated__prompt_kernel_ld1b
  s_mov_b32 s70, 0
  v_mov_b32 v33, 0
  global_load_dword v32, v33, s[100:101] sc1
gated_mix__softmax_full_mha__sliding_local_dilated__prompt_kernel_ld2:
  s_waitcnt vmcnt(16)
  s_barrier
  s_lshl_b32 s86, s70, 7
  s_add_u32 s87, s84, s71
  s_add_u32 m0, s87, 0
  s_nop 0
  buffer_load_dwordx4 v20, s[72:75], s86 offen lds
  s_add_u32 m0, s87, 1024
  s_nop 0
  buffer_load_dwordx4 v21, s[72:75], s86 offen lds
  s_add_u32 m0, s87, 2048
  s_nop 0
  buffer_load_dwordx4 v22, s[72:75], s86 offen lds
  s_add_u32 m0, s87, 3072
  s_nop 0
  buffer_load_dwordx4 v23, s[72:75], s86 offen lds
  s_mul_i32 s86, s70, 245760
  s_add_u32 s87, s85, s71
  s_add_u32 m0, s87, 0
  s_nop 0
  buffer_load_dwordx4 v24, s[80:83], s86 offen lds
  s_add_u32 s86, s86, 15360
  s_add_u32 m0, s87, 1024
  s_nop 0
  buffer_load_dwordx4 v24, s[80:83], s86 offen lds
  s_add_u32 s86, s86, 15360
  s_add_u32 m0, s87, 2048
  s_nop 0
  buffer_load_dwordx4 v24, s[80:83], s86 offen lds
  s_add_u32 s86, s86, 15360
  s_add_u32 m0, s87, 3072
  s_nop 0
  buffer_load_dwordx4 v24, s[80:83], s86 offen lds
  s_add_u32 s70, s70, 1
  s_add_u32 s71, s71, 32768
  s_and_b32 s71, s71, 131071
  s_cmp_lt_u32 s70, 10
  s_cbranch_scc1 gated_mix__softmax_full_mha__sliding_local_dilated__prompt_kernel_ld2
  s_waitcnt vmcnt(16)
  s_barrier
  s_cmp_lg_u32 s20, 4
  s_cbranch_scc1 gated_mix__softmax_full_mha__sliding_local_dilated__prompt_kernel_nopfi
  s_mov_b32 s90, 200000
  v_readfirstlane_b32 s66, v32
  s_nop 3
  s_cmp_lg_u32 s66, 0
  s_cbranch_scc1 gated_mix__softmax_full_mha__sliding_local_dilated__prompt_kernel_n3_ok
  v_mov_b32 v33, 0
gated_mix__softmax_full_mha__sliding_local_dilated__prompt_kernel_n3:
  global_load_dword v32, v33, s[100:101] sc1
  s_waitcnt vmcnt(0)
  v_readfirstlane_b32 s66, v32
  s_nop 3
  s_cmp_lg_u32 s66, 0
  s_cbranch_scc1 gated_mix__softmax_full_mha__sliding_local_dilated__prompt_kernel_n3_ok
  s_sub_u32 s90, s90, 1
  s_cmp_eq_u32 s90, 0
  s_cbranch_scc1 gated_mix__softmax_full_mha__sliding_local_dilated__prompt_kernel_n3_ok
  s_sleep 1
  s_branch gated_mix__softmax_full_mha__sliding_local_dilated__prompt_kernel_n3
gated_mix__softmax_full_mha__sliding_local_dilated__prompt_kernel_n3_ok:
  v_lshlrev_b32 v236, 4, v2
  s_and_b32 s91, s2, 31
  s_lshl_b32 s91, s91, 10
  s_add_u32 s91, s91, 26214400
  buffer_load_dwordx4 v[232:235], v236, s[16:19], s91 offen sc1
gated_mix__softmax_full_mha__sliding_local_dilated__prompt_kernel_nopfi:
  s_waitcnt vmcnt(8)
  s_barrier
  s_waitcnt vmcnt(0)
  s_cmp_lg_u32 s20, 4
  s_cbranch_scc1 gated_mix__softmax_full_mha__sliding_local_dilated__prompt_kernel_nopfa
  v_xor_b32 v232, s66, v232
  v_xor_b32 v233, s66, v233
  v_xor_b32 v234, s66, v234
  v_xor_b32 v235, s66, v235
  v_or3_b32 v232, v232, v233, v234
  v_or_b32 v232, v232, v235
  v_cmp_ne_u32 vcc, 0, v232
  s_nop 4
  s_cbranch_vccz gated_mix__softmax_full_mha__sliding_local_dilated__prompt_kernel_pfa_early
  v_lshlrev_b32 v240, 4, v2
  s_and_b32 s91, s2, 31
  s_lshl_b32 s91, s91, 10
  s_add_u32 s91, s91, 26214400
  s_mov_b32 s90, 200000
gated_mix__softmax_full_mha__sliding_local_dilated__prompt_kernel_pfa:
  buffer_load_dwordx4 v[232:235], v240, s[16:19], s91 offen sc1
  s_waitcnt vmcnt(0)
  v_xor_b32 v232, s66, v232
  v_xor_b32 v233, s66, v233
  v_xor_b32 v234, s66, v234
  v_xor_b32 v235, s66, v235
  v_or3_b32 v232, v232, v233, v234
  v_or_b32 v232, v232, v235
  v_cmp_ne_u32 vcc, 0, v232
  s_nop 4
  s_cbranch_vccz gated_mix__softmax_full_mha__sliding_local_dilated__prompt_kernel_pfa_ok
  s_sub_u32 s90, s90, 1
  s_cmp_eq_u32 s90, 0
  s_cbranch_scc1 gated_mix__softmax_full_mha__sliding_local_dilated__prompt_kernel_pfa_ok
  s_sleep 1
  s_branch gated_mix__softmax_full_mha__sliding_local_dilated__prompt_kernel_pfa
gated_mix__softmax_full_mha__sliding_local_dilated__prompt_kernel_pfa_ok:
gated_mix__softmax_full_mha__sliding_local_dilated__prompt_kernel_pfa_early:
gated_mix__softmax_full_mha__sliding_local_dilated__prompt_kernel_nopfa:
  s_barrier
  s_sub_u32 s8, s20, 4
  s_lshl_b32 s9, s8, 10
  v_lshlrev_b32 v28, 4, v2
  v_add_u32 v29, s9, v28
  s_add_u32 m0, s9, 0
  s_add_u32 s30, s26, 0
  buffer_load_dwordx4 v29, s[16:19], s30 offen sc1 lds
  s_add_u32 m0, s9, 4096
  s_add_u32 s30, s26, 4096
  buffer_load_dwordx4 v29, s[16:19], s30 offen sc1 lds
  s_add_u32 m0, s9, 8192
  s_add_u32 s30, s26, 8192
  buffer_load_dwordx4 v29, s[16:19], s30 offen sc1 lds
  s_add_u32 m0, s9, 12288
  s_add_u32 s30, s26, 12288
  buffer_load_dwordx4 v29, s[16:19], s30 offen sc1 lds
  s_add_u32 m0, s9, 16384
  s_add_u32 s30, s26, 16384
  buffer_load_dwordx4 v29, s[16:19], s30 offen sc1 lds
  s_add_u32 m0, s9, 20480
  s_add_u32 s30, s26, 20480
  buffer_load_dwordx4 v29, s[16:19], s30 offen sc1 lds
  s_add_u32 m0, s9, 24576
  s_add_u32 s30, s26, 24576
  buffer_load_dwordx4 v29, s[16:19], s30 offen sc1 lds
  s_add_u32 m0, s9, 28672
  s_add_u32 s30, s26, 28672
  buffer_load_dwordx4 v29, s[16:19], s30 offen sc1 lds
  s_add_u32 m0, s9, 32768
  s_add_u32 s30, s26, 32768
  buffer_load_dwordx4 v29, s[16:19], s30 offen sc1 lds
  s_add_u32 m0, s9, 36864
  s_add_u32 s30, s26, 36864
  buffer_load_dwordx4 v29, s[16:19], s30 offen sc1 lds
  s_add_u32 m0, s9, 40960
  s_add_u32 s30, s26, 40960
  buffer_load_dwordx4 v29, s[16:19], s30 offen sc1 lds
  s_barrier
  s_lshl_b32 s12, s22, 2
  s_lshl_b32 s13, s24, 1
  s_add_u32 s12, s12, s13
  s_mul_i32 s12, s12, 2560
  s_mul_i32 s13, s21, 163840
  s_add_u32 s12, s12, s13
  s_add_u32 s12, s12, 0
  s_add_u32 s13, s12, 2560
  buffer_load_dwordx4 v[16:19], v244, s[16:19], s12 offen sc1
  buffer_load_dwordx2 v[24:25], v245, s[16:19], s12 offen sc1
  buffer_load_dwordx4 v[20:23], v244, s[16:19], s13 offen sc1
  buffer_load_dwordx2 v[26:27], v245, s[16:19], s13 offen sc1
  s_waitcnt vmcnt(0)
  s_mov_b32 s3, 0
  s_branch gated_mix__softmax_full_mha__sliding_local_dilated__prompt_kernel_attn
gated_mix__softmax_full_mha__sliding_local_dilated__prompt_kernel_gate:
  s_lshl_b32 s91, s2, 3
  s_or_b32 s91, s91, s20
  s_cmp_lg_u32 s91, 1800
  s_cbranch_scc1 gated_mix__softmax_full_mha__sliding_local_dilated__prompt_kernel_notag
  s_mov_b64 exec, 1
  v_mov_b32 v4, 26288128
  buffer_load_dword v3, v4, s[16:19], 0 offen sc1
  s_waitcnt vmcnt(0)
  v_add_u32 v3, 1, v3
  v_max_u32 v3, 1, v3
  buffer_store_dword v3, v4, s[16:19], 0 offen sc1
  v_mov_b32 v4, 0
  global_store_dword v4, v3, s[100:101] sc1
  s_mov_b64 exec, -1
gated_mix__softmax_full_mha__sliding_local_dilated__prompt_kernel_notag:
  s_and_b32 s24, s2, 7
  s_lshr_b32 s24, s24, 1
  s_lshl_b32 s24, s24, 2
  s_lshr_b32 s25, s2, 3
  s_sub_u32 s25, s25, 28
  s_add_u32 s26, s24, s25
  s_lshl_b32 s26, s26, 7
  s_lshl_b32 s27, s20, 4
  s_add_u32 s26, s26, s27
  v_lshrrev_b32 v3, 2, v2
  v_add_u32 v3, s26, v3
  v_and_b32 v4, 3, v2
  v_lshlrev_b32 v5, 4, v4
  s_movk_i32 s33, 1280
  v_mad_u32_u24 v6, v3, s33, v5
  buffer_load_dwordx4 v[8:11], v6, s[8:11], 0 offen offset:0
  buffer_load_dwordx4 v[88:91], v5, s[48:51], 0 offen offset:0
  buffer_load_dwordx4 v[12:15], v6, s[8:11], 0 offen offset:64
  buffer_load_dwordx4 v[92:95], v5, s[48:51], 0 offen offset:64
  buffer_load_dwordx4 v[16:19], v6, s[8:11], 0 offen offset:128
  buffer_load_dwordx4 v[96:99], v5, s[48:51], 0 offen offset:128
  buffer_load_dwordx4 v[20:23], v6, s[8:11], 0 offen offset:192
  buffer_load_dwordx4 v[100:103], v5, s[48:51], 0 offen offset:192
  buffer_load_dwordx4 v[24:27], v6, s[8:11], 0 offen offset:256
  buffer_load_dwordx4 v[104:107], v5, s[48:51], 0 offen offset:256
  buffer_load_dwordx4 v[28:31], v6, s[8:11], 0 offen offset:320
  buffer_load_dwordx4 v[108:111], v5, s[48:51], 0 offen offset:320
  buffer_load_dwordx4 v[32:35], v6, s[8:11], 0 offen offset:384
  buffer_load_dwordx4 v[112:115], v5, s[48:51], 0 offen offset:384
  buffer_load_dwordx4 v[36:39], v6, s[8:11], 0 offen offset:448
  buffer_load_dwordx4 v[116:119], v5, s[48:51], 0 offen offset:448
  buffer_load_dwordx4 v[40:43], v6, s[8:11], 0 offen offset:512
  buffer_load_dwordx4 v[120:123], v5, s[48:51], 0 offen offset:512
  buffer_load_dwordx4 v[44:47], v6, s[8:11], 0 offen offset:576
  buffer_load_dwordx4 v[124:127], v5, s[48:51], 0 offen offset:576
  buffer_load_dwordx4 v[48:51], v6, s[8:11], 0 offen offset:640
  buffer_load_dwordx4 v[128:131], v5, s[48:51], 0 offen offset:640
  buffer_load_dwordx4 v[52:55], v6, s[8:11], 0 offen offset:704
  buffer_load_dwordx4 v[132:135], v5, s[48:51], 0 offen offset:704
  buffer_load_dwordx4 v[56:59], v6, s[8:11], 0 offen offset:768
  buffer_load_dwordx4 v[136:139], v5, s[48:51], 0 offen offset:768
  buffer_load_dwordx4 v[60:63], v6, s[8:11], 0 offen offset:832
  buffer_load_dwordx4 v[140:143], v5, s[48:51], 0 offen offset:832
  buffer_load_dwordx4 v[64:67], v6, s[8:11], 0 offen offset:896
  buffer_load_dwordx4 v[144:147], v5, s[48:51], 0 offen offset:896
  buffer_load_dwordx4 v[68:71], v6, s[8:11], 0 offen offset:960
  buffer_load_dwordx4 v[148:151], v5, s[48:51], 0 offen offset:960
  buffer_load_dwordx4 v[72:75], v6, s[8:11], 0 offen offset:1024
  buffer_load_dwordx4 v[152:155], v5, s[48:51], 0 offen offset:1024
  buffer_load_dwordx4 v[76:79], v6, s[8:11], 0 offen offset:1088
  buffer_load_dwordx4 v[156:159], v5, s[48:51], 0 offen offset:1088
  buffer_load_dwordx4 v[80:83], v6, s[8:11], 0 offen offset:1152
  buffer_load_dwordx4 v[160:163], v5, s[48:51], 0 offen offset:1152
  buffer_load_dwordx4 v[84:87], v6, s[8:11], 0 offen offset:1216
  buffer_load_dwordx4 v[164:167], v5, s[48:51], 0 offen offset:1216
  v_mov_b32 v168, 0
  v_mov_b32 v169, 0
  v_mov_b32 v170, 0
  v_mov_b32 v171, 0
  s_waitcnt vmcnt(38)
  v_dot2_f32_bf16 v168, v8, v88, v168
  v_dot2_f32_bf16 v169, v9, v89, v169
  v_dot2_f32_bf16 v170, v10, v90, v170
  v_dot2_f32_bf16 v171, v11, v91, v171
  s_waitcnt vmcnt(36)
  v_dot2_f32_bf16 v168, v12, v92, v168
  v_dot2_f32_bf16 v169, v13, v93, v169
  v_dot2_f32_bf16 v170, v14, v94, v170
  v_dot2_f32_bf16 v171, v15, v95, v171
  s_waitcnt vmcnt(34)
  v_dot2_f32_bf16 v168, v16, v96, v168
  v_dot2_f32_bf16 v169, v17, v97, v169
  v_dot2_f32_bf16 v170, v18, v98, v170
  v_dot2_f32_bf16 v171, v19, v99, v171
  s_waitcnt vmcnt(32)
  v_dot2_f32_bf16 v168, v20, v100, v168
  v_dot2_f32_bf16 v169, v21, v101, v169
  v_dot2_f32_bf16 v170, v22, v102, v170
  v_dot2_f32_bf16 v171, v23, v103, v171
  s_waitcnt vmcnt(30)
  v_dot2_f32_bf16 v168, v24, v104, v168
  v_dot2_f32_bf16 v169, v25, v105, v169
  v_dot2_f32_bf16 v170, v26, v106, v170
  v_dot2_f32_bf16 v171, v27, v107, v171
  s_waitcnt vmcnt(28)
  v_dot2_f32_bf16 v168, v28, v108, v168
  v_dot2_f32_bf16 v169, v29, v109, v169
  v_dot2_f32_bf16 v170, v30, v110, v170
  v_dot2_f32_bf16 v171, v31, v111, v171
  s_waitcnt vmcnt(26)
  v_dot2_f32_bf16 v168, v32, v112, v168
  v_dot2_f32_bf16 v169, v33, v113, v169
  v_dot2_f32_bf16 v170, v34, v114, v170
  v_dot2_f32_bf16 v171, v35, v115, v171
  s_waitcnt vmcnt(24)
  v_dot2_f32_bf16 v168, v36, v116, v168
  v_dot2_f32_bf16 v169, v37, v117, v169
  v_dot2_f32_bf16 v170, v38, v118, v170
  v_dot2_f32_bf16 v171, v39, v119, v171
  s_waitcnt vmcnt(22)
  v_dot2_f32_bf16 v168, v40, v120, v168
  v_dot2_f32_bf16 v169, v41, v121, v169
  v_dot2_f32_bf16 v170, v42, v122, v170
  v_dot2_f32_bf16 v171, v43, v123, v171
  s_waitcnt vmcnt(20)
  v_dot2_f32_bf16 v168, v44, v124, v168
  v_dot2_f32_bf16 v169, v45, v125, v169
  v_dot2_f32_bf16 v170, v46, v126, v170
  v_dot2_f32_bf16 v171, v47, v127, v171
  s_waitcnt vmcnt(18)
  v_dot2_f32_bf16 v168, v48, v128, v168
  v_dot2_f32_bf16 v169, v49, v129, v169
  v_dot2_f32_bf16 v170, v50, v130, v170
  v_dot2_f32_bf16 v171, v51, v131, v171
  s_waitcnt vmcnt(16)
  v_dot2_f32_bf16 v168, v52, v132, v168
  v_dot2_f32_bf16 v169, v53, v133, v169
  v_dot2_f32_bf16 v170, v54, v134, v170
  v_dot2_f32_bf16 v171, v55, v135, v171
  s_waitcnt vmcnt(14)
  v_dot2_f32_bf16 v168, v56, v136, v168
  v_dot2_f32_bf16 v169, v57, v137, v169
  v_dot2_f32_bf16 v170, v58, v138, v170
  v_dot2_f32_bf16 v171, v59, v139, v171
  s_waitcnt vmcnt(12)
  v_dot2_f32_bf16 v168, v60, v140, v168
  v_dot2_f32_bf16 v169, v61, v141, v169
  v_dot2_f32_bf16 v170, v62, v142, v170
  v_dot2_f32_bf16 v171, v63, v143, v171
  s_waitcnt vmcnt(10)
  v_dot2_f32_bf16 v168, v64, v144, v168
  v_dot2_f32_bf16 v169, v65, v145, v169
  v_dot2_f32_bf16 v170, v66, v146, v170
  v_dot2_f32_bf16 v171, v67, v147, v171
  s_waitcnt vmcnt(8)
  v_dot2_f32_bf16 v168, v68, v148, v168
  v_dot2_f32_bf16 v169, v69, v149, v169
  v_dot2_f32_bf16 v170, v70, v150, v170
  v_dot2_f32_bf16 v171, v71, v151, v171
  s_waitcnt vmcnt(6)
  v_dot2_f32_bf16 v168, v72, v152, v168
  v_dot2_f32_bf16 v169, v73, v153, v169
  v_dot2_f32_bf16 v170, v74, v154, v170
  v_dot2_f32_bf16 v171, v75, v155, v171
  s_waitcnt vmcnt(4)
  v_dot2_f32_bf16 v168, v76, v156, v168
  v_dot2_f32_bf16 v169, v77, v157, v169
  v_dot2_f32_bf16 v170, v78, v158, v170
  v_dot2_f32_bf16 v171, v79, v159, v171
  s_waitcnt vmcnt(2)
  v_dot2_f32_bf16 v168, v80, v160, v168
  v_dot2_f32_bf16 v169, v81, v161, v169
  v_dot2_f32_bf16 v170, v82, v162, v170
  v_dot2_f32_bf16 v171, v83, v163, v171
  s_waitcnt vmcnt(0)
  v_dot2_f32_bf16 v168, v84, v164, v168
  v_dot2_f32_bf16 v169, v85, v165, v169
  v_dot2_f32_bf16 v170, v86, v166, v170
  v_dot2_f32_bf16 v171, v87, v167, v171
  s_nop 0
  v_add_f32 v168, v168, v169
  s_nop 0
  v_add_f32 v170, v170, v171
  v_add_f32 v168, v168, v170
  s_nop 1
  v_add_f32_dpp v169, v168, v168 quad_perm:[1,0,3,2] row_mask:0xf bank_mask:0xf
  s_nop 1
  v_add_f32_dpp v168, v169, v169 quad_perm:[2,3,0,1] row_mask:0xf bank_mask:0xf
  v_mul_f32 v168, 0xbfb8aa3b, v168
  v_exp_f32 v168, v168
  s_nop 0
  v_add_f32 v168, 1.0, v168
  v_rcp_f32 v168, v168
  v_lshlrev_b32 v3, 2, v3
  v_add_u32 v3, 25165824, v3
  v_cmp_eq_u32 vcc, 0, v4
  s_nop 3
  s_and_saveexec_b64 s[30:31], vcc
  s_cbranch_execz gated_mix__softmax_full_mha__sliding_local_dilated__prompt_kernel_gskip
  buffer_store_dword v168, v3, s[16:19], 0 offen sc1
gated_mix__softmax_full_mha__sliding_local_dilated__prompt_kernel_gskip:
  s_mov_b64 exec, s[30:31]
  s_waitcnt vmcnt(0)
  s_barrier
  s_cmp_lg_u32 s20, 0
  s_cbranch_scc1 gated_mix__softmax_full_mha__sliding_local_dilated__prompt_kernel_gpub
  s_lshl_b32 s25, s2, 2
  s_add_u32 s24, s25, 26214400
  v_mov_b32 v15, 0
  buffer_load_dword v13, v15, s[16:19], s24 offen sc1
  s_mov_b32 s90, 200000
gated_mix__softmax_full_mha__sliding_local_dilated__prompt_kernel_gtag:
  global_load_dword v14, v15, s[100:101] sc1
  s_waitcnt vmcnt(0)
  v_readfirstlane_b32 s66, v14
  v_readfirstlane_b32 s91, v13
  s_nop 2
  s_cmp_eq_u32 s66, 0
  s_cbranch_scc1 gated_mix__softmax_full_mha__sliding_local_dilated__prompt_kernel_gtag_again
  s_cmp_lg_u32 s66, s91
  s_cbranch_scc1 gated_mix__softmax_full_mha__sliding_local_dilated__prompt_kernel_gtag_ok
gated_mix__softmax_full_mha__sliding_local_dilated__prompt_kernel_gtag_again:
  s_sub_u32 s90, s90, 1
  s_cmp_eq_u32 s90, 0
  s_cbranch_scc1 gated_mix__softmax_full_mha__sliding_local_dilated__prompt_kernel_gtag_ok
  s_sleep 1
  s_branch gated_mix__softmax_full_mha__sliding_local_dilated__prompt_kernel_gtag
gated_mix__softmax_full_mha__sliding_local_dilated__prompt_kernel_gtag_ok:
  v_lshlrev_b32 v5, 10, v2
  v_mov_b32 v4, s66
  s_mov_b32 exec_hi, 0
  buffer_store_dword v4, v5, s[16:19], s24 offen sc1
  s_mov_b64 exec, -1
  s_add_u32 s24, s25, 26247168
  v_lshlrev_b32 v5, 10, v2
  v_mov_b32 v4, s66
  s_mov_b32 exec_hi, 0
  buffer_store_dword v4, v5, s[16:19], s24 offen sc1
  s_mov_b64 exec, -1
gated_mix__softmax_full_mha__sliding_local_dilated__prompt_kernel_gpub:
  s_and_b32 s8, s2, 7
  s_lshr_b32 s9, s2, 3
  s_and_b32 s10, s9, 1
  s_lshl_b32 s8, s8, 1
  s_add_u32 s21, s8, s10
  s_lshr_b32 s22, s9, 1
  s_and_b32 s23, s20, 1
  s_bfe_u32 s24, s20, 0x10001
  s_lshr_b32 s25, s20, 2
  s_mov_b32 s32, -1
  s_mov_b32 s33, 0
  s_cmp_eq_u32 s23, 0
  s_cselect_b32 s34, -1, 0
  s_cselect_b32 s35, 0, -1
  v_and_b32 v8, 31, v2
  v_lshrrev_b32 v9, 5, v2
  s_mul_i32 s10, s21, 360448
  s_add_u32 s26, s10, 6291456
  s_mul_i32 s9, s23, 1536
  v_lshlrev_b32 v10, 4, v8
  v_lshlrev_b32 v11, 9, v9
  v_add3_u32 v244, v10, v11, s9
  v_lshlrev_b32 v12, 3, v9
  v_add_u32 v12, v10, v12
  v_add_u32 v245, 1024, v12
  s_mul_i32 s9, s23, 1536
  v_mul_u32_u24 v11, 384, v9
  v_min_u32 v13, 21, v8
  v_lshlrev_b32 v13, 4, v13
  v_add3_u32 v13, v13, v11, s9
  v_add_u32 v0, 2560, v13
  s_mul_i32 s9, s25, 22528
  v_add_u32 v3, s9, v244
  v_add_u32 v4, s9, v245
  v_add_u32 v5, s9, v0
  s_lshl_b32 s28, s20, 10
  v_lshlrev_b32 v12, 4, v2
  v_add_u32 v6, s28, v12
  s_lshl_b32 s9, s20, 9
  s_add_u32 s38, s9, 40960
  v_add_u32 v7, s38, v12
  s_lshl_b32 s8, s22, 2
  s_lshl_b32 s9, s24, 1
  s_add_u32 s8, s8, s9
  s_add_u32 s39, s8, s25
  s_mul_i32 s8, s39, 2560
  s_mul_i32 s9, s21, 163840
  s_add_u32 s8, s8, s9
  s_add_u32 s8, s8, 18874368
  s_lshl_b32 s9, s23, 10
  s_add_u32 s9, s9, s8
  v_lshlrev_b32 v11, 9, v9
  v_add3_u32 v14, v10, v11, s9
  s_lshl_b32 s9, s23, 8
  s_add_u32 s9, s9, s8
  s_add_u32 s9, s9, 2048
  v_lshrrev_b32 v11, 1, v10
  v_add_u32 v1, s9, v11
  s_mul_i32 s8, s20, 3328
  s_add_u32 s8, s8, 0
  v_add_u32 v15, s8, v12
  s_lshl_b32 s8, s39, 5
  v_add_u32 v10, s8, v8
  v_lshlrev_b32 v10, 2, v10
  v_add_u32 v216, 25165824, v10
  s_lshl_b32 s8, s22, 7
  s_lshl_b32 s9, s25, 6
  s_add_u32 s8, s8, s9
  s_add_u32 s8, s8, s24
  v_lshlrev_b32 v10, 1, v8
  v_add_u32 v10, s8, v10
  v_lshlrev_b32 v10, 2, v10
  v_add_u32 v227, 25165824, v10
  v_cndmask_b32 v228, 0, -1, s[34:35]
  v_lshlrev_b32 v10, 2, v9
  v_sub_u32 v10, v8, v10
  v_mov_b32 v13, 0xf149f2ca
  v_subrev_u32 v11, 0, v10
  v_cmp_gt_u32 s[50:51], 8, v11
  v_subrev_u32 v12, 1, v10
  v_cmp_gt_u32 s[52:53], 8, v12
  v_subrev_u32 v11, 2, v10
  v_cmp_gt_u32 s[54:55], 8, v11
  v_subrev_u32 v12, 3, v10
  v_cmp_gt_u32 s[56:57], 8, v12
  v_cndmask_b32 v166, v13, 0, s[50:51]
  v_cndmask_b32 v167, v13, 0, s[52:53]
  v_cndmask_b32 v168, v13, 0, s[54:55]
  v_cndmask_b32 v169, v13, 0, s[56:57]
  v_subrev_u32 v11, 8, v10
  v_cmp_gt_u32 s[50:51], 8, v11
  v_subrev_u32 v12, 9, v10
  v_cmp_gt_u32 s[52:53], 8, v12
  v_subrev_u32 v11, 10, v10
  v_cmp_gt_u32 s[54:55], 8, v11
  v_subrev_u32 v12, 11, v10
  v_cmp_gt_u32 s[56:57], 8, v12
  v_cndmask_b32 v170, v13, 0, s[50:51]
  v_cndmask_b32 v171, v13, 0, s[52:53]
  v_cndmask_b32 v172, v13, 0, s[54:55]
  v_cndmask_b32 v173, v13, 0, s[56:57]
  v_subrev_u32 v11, 16, v10
  v_cmp_gt_u32 s[50:51], 8, v11
  v_subrev_u32 v12, 17, v10
  v_cmp_gt_u32 s[52:53], 8, v12
  v_subrev_u32 v11, 18, v10
  v_cmp_gt_u32 s[54:55], 8, v11
  v_subrev_u32 v12, 19, v10
  v_cmp_gt_u32 s[56:57], 8, v12
  v_cndmask_b32 v174, v13, 0, s[50:51]
  v_cndmask_b32 v175, v13, 0, s[52:53]
  v_cndmask_b32 v176, v13, 0, s[54:55]
  v_cndmask_b32 v177, v13, 0, s[56:57]
  v_subrev_u32 v11, 24, v10
  v_cmp_gt_u32 s[50:51], 8, v11
  v_subrev_u32 v12, 25, v10
  v_cmp_gt_u32 s[52:53], 8, v12
  v_subrev_u32 v11, 26, v10
  v_cmp_gt_u32 s[54:55], 8, v11
  v_subrev_u32 v12, 27, v10
  v_cmp_gt_u32 s[56:57], 8, v12
  v_cndmask_b32 v178, v13, 0, s[50:51]
  v_cndmask_b32 v179, v13, 0, s[52:53]
  v_cndmask_b32 v180, v13, 0, s[54:55]
  v_cndmask_b32 v181, v13, 0, s[56:57]
  s_cmp_eq_u32 s25, 1
  s_cselect_b32 s9, 1, 3
  s_cmp_lt_u32 s39, s9
  s_cselect_b32 s9, 1000, 0
  v_add_u32 v11, s9, v10
  v_cmp_gt_i32 s[50:51], 0, v11
  v_cmp_gt_i32 s[52:53], 1, v11
  v_cmp_gt_i32 s[54:55], 2, v11
  v_cmp_gt_i32 s[56:57], 3, v11
  v_cndmask_b32 v194, v13, 0, s[50:51]
  v_cndmask_b32 v195, v13, 0, s[52:53]
  v_cndmask_b32 v196, v13, 0, s[54:55]
  v_cndmask_b32 v197, v13, 0, s[56:57]
  v_mov_b32 v206, 0
  v_mov_b32 v207, 0
  s_load_dwordx2 s[4:5], s[0:1], 16
  s_load_dwordx2 s[6:7], s[0:1], 40
  s_load_dwordx2 s[36:37], s[0:1], 56
  s_and_b32 s8, s2, 7
  s_lshr_b32 s9, s2, 3
  s_lshr_b32 s10, s8, 1
  s_lshl_b32 s10, s10, 3
  s_lshr_b32 s11, s9, 2
  s_add_u32 s42, s10, s11
  s_and_b32 s8, s8, 1
  s_lshl_b32 s8, s8, 2
  s_and_b32 s9, s9, 3
  s_add_u32 s43, s8, s9
  s_and_b32 s48, s20, 1
  s_lshr_b32 s49, s20, 1
  s_waitcnt lgkmcnt(0)
  s_mov_b32 s60, s4
  s_mov_b32 s61, s5
  s_mov_b32 s62, 819200
  s_mov_b32 s63, 0x20000
  s_mov_b32 s44, s6
  s_mov_b32 s45, s7
  s_mov_b32 s46, 819200
  s_mov_b32 s47, 0x20000
  s_mov_b32 s96, s36
  s_mov_b32 s97, s37
  s_mov_b32 s98, 2621440
  s_mov_b32 s99, 0x20000
  v_and_b32 v8, 31, v2
  v_lshrrev_b32 v9, 5, v2
  v_mul_u32_u24 v10, 43, v2
  v_lshrrev_b32 v10, 9, v10
  v_mul_u32_u24 v11, 12, v10
  v_sub_u32 v11, v2, v11
  s_mul_i32 s8, s20, 40
  v_add_u32 v12, s8, v10
  s_movk_i32 s9, 1280
  s_mul_i32 s10, s43, 160
  v_lshlrev_b32 v13, 4, v11
  v_add_u32 v13, s10, v13
  v_mad_u32_u24 v221, v12, s9, v13
  v_cmp_gt_u32 s[50:51], 10, v11
  v_cmp_gt_u32 s[52:53], 60, v2
  s_nop 3
  s_and_b64 s[58:59], s[50:51], s[52:53]
  s_mul_i32 s65, s20, 7680
  v_bfe_u32 v10, v2, 2, 2
  s_mul_i32 s8, s49, 80
  v_add_u32 v10, s8, v10
  v_bfe_u32 v11, v2, 4, 1
  v_lshlrev_b32 v11, 5, v11
  v_and_b32 v12, 3, v2
  v_lshlrev_b32 v12, 3, v12
  v_add_u32 v11, v11, v12
  v_lshlrev_b32 v12, 2, v9
  v_add_u32 v12, v10, v12
  v_mul_u32_u24 v12, 192, v12
  v_add_u32 v12, v12, v11
  v_add_u32 v217, 102400, v12
  v_add_u32 v219, 26624, v12
  v_mul_u32_u24 v12, 40, v9
  v_add3_u32 v12, v10, v12, 16
  v_mul_u32_u24 v12, 192, v12
  v_add_u32 v12, v12, v11
  v_add_u32 v218, 102400, v12
  v_add_u32 v220, 26624, v12
  s_mul_i32 s8, s49, 327680
  s_add_u32 s8, s8, 18874368
  s_lshl_b32 s9, s42, 1
  s_add_u32 s9, s9, s48
  s_mul_i32 s10, s9, 2560
  s_add_u32 s10, s10, s8
  v_lshlrev_b32 v10, 4, v8
  v_lshlrev_b32 v11, 9, v9
  v_add3_u32 v223, v10, v11, s10
  s_mov_b32 s11, 163840
  v_mul_lo_u32 v12, v9, s11
  s_add_u32 s10, s10, 2048
  v_lshrrev_b32 v13, 1, v10
  v_add3_u32 v224, v13, v12, s10
  s_lshr_b32 s10, s42, 1
  s_lshl_b32 s10, s10, 2
  s_and_b32 s13, s42, 1
  s_add_u32 s10, s10, s13
  s_mul_i32 s10, s10, 2560
  s_add_u32 s10, s10, s8
  s_lshl_b32 s13, s48, 8
  s_add_u32 s10, s10, s13
  s_add_u32 s10, s10, 2621440
  v_lshrrev_b32 v10, 1, v8
  v_and_b32 v13, 1, v8
  v_mul_u32_u24 v13, 5120, v13
  v_add_u32 v12, v12, v13
  v_add_u32 v11, v11, v13
  v_lshlrev_b32 v13, 4, v10
  v_add3_u32 v225, v13, v11, s10
  s_lshl_b32 s13, s48, 7
  s_sub_u32 s10, s10, s13
  s_add_u32 s10, s10, 2048
  v_lshlrev_b32 v13, 3, v10
  v_add3_u32 v226, v13, v12, s10
  s_lshl_b32 s10, s9, 5
  v_add_u32 v10, s10, v8
  s_mul_i32 s10, s43, 160
  s_lshl_b32 s11, s49, 4
  s_add_u32 s10, s10, s11
  v_mul_u32_u24 v10, 1280, v10
  v_add_u32 v222, s10, v10
  s_lshr_b32 s64, s42, 1
  s_cmp_lg_u32 s20, 0
  s_cbranch_scc1 gated_mix__softmax_full_mha__sliding_local_dilated__prompt_kernel_gnopfa
  v_lshlrev_b32 v36, 4, v2
  s_and_b32 s91, s2, 31
  s_lshl_b32 s91, s91, 10
  s_add_u32 s91, s91, 26214400
  s_mov_b32 s90, 200000
gated_mix__softmax_full_mha__sliding_local_dilated__prompt_kernel_pfag:
  buffer_load_dwordx4 v[28:31], v36, s[16:19], s91 offen sc1
  s_waitcnt vmcnt(0)
  v_xor_b32 v28, s66, v28
  v_xor_b32 v29, s66, v29
  v_xor_b32 v30, s66, v30
  v_xor_b32 v31, s66, v31
  v_or3_b32 v28, v28, v29, v30
  v_or_b32 v28, v28, v31
  v_cmp_ne_u32 vcc, 0, v28
  s_nop 4
  s_cbranch_vccz gated_mix__softmax_full_mha__sliding_local_dilated__prompt_kernel_pfag_ok
  s_sub_u32 s90, s90, 1
  s_cmp_eq_u32 s90, 0
  s_cbranch_scc1 gated_mix__softmax_full_mha__sliding_local_dilated__prompt_kernel_pfag_ok
  s_sleep 1
  s_branch gated_mix__softmax_full_mha__sliding_local_dilated__prompt_kernel_pfag
gated_mix__softmax_full_mha__sliding_local_dilated__prompt_kernel_pfag_ok:
gated_mix__softmax_full_mha__sliding_local_dilated__prompt_kernel_gnopfa:
  s_barrier
  s_add_u32 m0, s28, 0
  s_add_u32 s30, s26, 0
  buffer_load_dwordx4 v6, s[16:19], s30 offen sc1 lds
  s_add_u32 m0, s28, 8192
  s_add_u32 s30, s26, 8192
  buffer_load_dwordx4 v6, s[16:19], s30 offen sc1 lds
  s_add_u32 m0, s28, 16384
  s_add_u32 s30, s26, 16384
  buffer_load_dwordx4 v6, s[16:19], s30 offen sc1 lds
  s_add_u32 m0, s28, 24576
  s_add_u32 s30, s26, 24576
  buffer_load_dwordx4 v6, s[16:19], s30 offen sc1 lds
  s_add_u32 m0, s28, 32768
  s_add_u32 s30, s26, 32768
  buffer_load_dwordx4 v6, s[16:19], s30 offen sc1 lds
  s_add_u32 m0, s38, 0
  s_add_u32 s30, s26, 0
  s_mov_b32 exec_hi, 0
  buffer_load_dwordx4 v7, s[16:19], s30 offen sc1 lds
  s_mov_b64 exec, -1
  s_lshl_b32 s8, s22, 2
  s_lshl_b32 s9, s24, 1
  s_add_u32 s8, s8, s9
  s_mul_i32 s8, s8, 2560
  s_mul_i32 s9, s21, 163840
  s_add_u32 s8, s8, s9
  s_add_u32 s8, s8, 0
  s_add_u32 s9, s8, 2560
  buffer_load_dwordx4 v[16:19], v244, s[16:19], s8 offen sc1
  buffer_load_dwordx2 v[24:25], v245, s[16:19], s8 offen sc1
  buffer_load_dwordx4 v[20:23], v244, s[16:19], s9 offen sc1
  buffer_load_dwordx2 v[26:27], v245, s[16:19], s9 offen sc1
  s_waitcnt vmcnt(0)
  s_mov_b32 s3, 0
gated_mix__softmax_full_mha__sliding_local_dilated__prompt_kernel_attn:
  v_mov_b32 v10, 0
  v_mov_b32 v11, 98304
  ds_write_b32 v11, v10
  ds_write_b32 v11, v10 offset:4
  v_mov_b32 v104, 0
  v_mov_b32 v105, 0
  v_mov_b32 v106, 0
  v_mov_b32 v107, 0
  v_mov_b32 v108, 0
  v_mov_b32 v109, 0
  v_mov_b32 v110, 0
  v_mov_b32 v111, 0
  v_mov_b32 v112, 0
  v_mov_b32 v113, 0
  v_mov_b32 v114, 0
  v_mov_b32 v115, 0
  v_mov_b32 v116, 0
  v_mov_b32 v117, 0
  v_mov_b32 v118, 0
  v_mov_b32 v119, 0
  v_mov_b32 v120, 0
  v_mov_b32 v121, 0
  v_mov_b32 v122, 0
  v_mov_b32 v123, 0
  v_mov_b32 v124, 0
  v_mov_b32 v125, 0
  v_mov_b32 v126, 0
  v_mov_b32 v127, 0
  v_mov_b32 v128, 0
  v_mov_b32 v129, 0
  v_mov_b32 v130, 0
  v_mov_b32 v131, 0
  v_mov_b32 v132, 0
  v_mov_b32 v133, 0
  v_mov_b32 v134, 0
  v_mov_b32 v135, 0
  v_mov_b32 v52, 0
  v_mov_b32 v68, 0
  v_mov_b32 v53, 0
  v_mov_b32 v69, 0
  v_mov_b32 v54, 0
  v_mov_b32 v70, 0
  v_mov_b32 v55, 0
  v_mov_b32 v71, 0
  v_and_b32 v24, v228, v24
  v_and_b32 v25, v228, v25
  v_and_b32 v26, v228, v26
  v_and_b32 v27, v228, v27
  s_waitcnt lgkmcnt(0)
  s_barrier
  ds_read_b128 v[28:31], v3 offset:0
  ds_read_b64 v[32:33], v4 offset:0
  ds_read_b128 v[40:43], v5 offset:0
  ds_read_b128 v[44:47], v5 offset:768
  s_waitcnt lgkmcnt(2)
  v_mfma_f32_32x32x8bf16_1k v[72:87], v[32:33], v[24:25], 0
  v_mfma_f32_32x32x16_bf16 v[72:87], v[28:31], v[16:19], v[72:87]
  s_nop 7
  s_nop 3
  s_waitcnt lgkmcnt(0)
  v_mfma_f32_32x32x8bf16_1k v[88:103], v[32:33], v[26:27], 0
  ds_read_b64 v[38:39], v4 offset:5632
  s_add_u32 m0, s28, 45056
  s_add_u32 s30, s26, 45056
  buffer_load_dwordx4 v6, s[16:19], s30 offen sc1 lds
  v_exp_f32 v72, v72
  v_exp_f32 v73, v73
  v_exp_f32 v74, v74
  v_exp_f32 v75, v75
  v_cvt_pk_bf16_f32 v56, v72, v73
  v_cvt_pk_bf16_f32 v57, v74, v75
  v_mfma_f32_32x32x16_bf16 v[88:103], v[28:31], v[20:23], v[88:103]
  ds_read_b128 v[34:37], v3 offset:5632
  s_add_u32 m0, s28, 53248
  s_add_u32 s30, s26, 53248
  buffer_load_dwordx4 v6, s[16:19], s30 offen sc1 lds
  v_exp_f32 v76, v76
  v_exp_f32 v77, v77
  v_exp_f32 v78, v78
  v_exp_f32 v79, v79
  v_cvt_pk_bf16_f32 v58, v76, v77
  v_cvt_pk_bf16_f32 v59, v78, v79
  v_mfma_f32_32x32x16_bf16 v[120:135], v[52:55], v[68:71], v[120:135]
  s_add_u32 m0, s28, 61440
  s_add_u32 s30, s26, 61440
  buffer_load_dwordx4 v6, s[16:19], s30 offen sc1 lds
  v_exp_f32 v80, v80
  v_exp_f32 v81, v81
  v_exp_f32 v82, v82
  v_exp_f32 v83, v83
  v_cvt_pk_bf16_f32 v60, v80, v81
  v_cvt_pk_bf16_f32 v61, v82, v83
  v_mfma_f32_32x32x16_bf16 v[104:119], v[40:43], v[56:59], v[104:119]
  s_add_u32 m0, s28, 69632
  s_add_u32 s30, s26, 69632
  buffer_load_dwordx4 v6, s[16:19], s30 offen sc1 lds
  v_exp_f32 v84, v84
  v_exp_f32 v85, v85
  v_exp_f32 v86, v86
  v_exp_f32 v87, v87
  v_cvt_pk_bf16_f32 v62, v84, v85
  v_cvt_pk_bf16_f32 v63, v86, v87
  s_waitcnt lgkmcnt(0)
  v_mfma_f32_32x32x8bf16_1k v[72:87], v[38:39], v[24:25], 0
  ds_read_b128 v[48:51], v5 offset:5632
  s_add_u32 m0, s28, 77824
  s_add_u32 s30, s26, 77824
  buffer_load_dwordx4 v6, s[16:19], s30 offen sc1 lds
  v_exp_f32 v88, v88
  v_exp_f32 v89, v89
  v_exp_f32 v90, v90
  v_exp_f32 v91, v91
  v_cvt_pk_bf16_f32 v64, v88, v89
  v_cvt_pk_bf16_f32 v65, v90, v91
  v_mfma_f32_32x32x16_bf16 v[72:87], v[34:37], v[16:19], v[72:87]
  ds_read_b128 v[52:55], v5 offset:6400
  s_add_u32 m0, s38, 45056
  s_add_u32 s30, s26, 45056
  s_mov_b32 exec_hi, 0
  buffer_load_dwordx4 v7, s[16:19], s30 offen sc1 lds
  s_mov_b64 exec, -1
  v_exp_f32 v92, v92
  v_exp_f32 v93, v93
  v_exp_f32 v94, v94
  v_exp_f32 v95, v95
  v_cvt_pk_bf16_f32 v66, v92, v93
  v_cvt_pk_bf16_f32 v67, v94, v95
  v_mfma_f32_32x32x16_bf16 v[104:119], v[44:47], v[60:63], v[104:119]
  v_exp_f32 v96, v96
  v_exp_f32 v97, v97
  v_exp_f32 v98, v98
  v_exp_f32 v99, v99
  v_cvt_pk_bf16_f32 v68, v96, v97
  v_cvt_pk_bf16_f32 v69, v98, v99
  v_mfma_f32_32x32x16_bf16 v[120:135], v[40:43], v[64:67], v[120:135]
  v_exp_f32 v100, v100
  v_exp_f32 v101, v101
  v_exp_f32 v102, v102
  v_exp_f32 v103, v103
  v_cvt_pk_bf16_f32 v70, v100, v101
  v_cvt_pk_bf16_f32 v71, v102, v103
  s_waitcnt lgkmcnt(0)
  v_mfma_f32_32x32x8bf16_1k v[88:103], v[38:39], v[26:27], 0
  ds_read_b64 v[32:33], v4 offset:11264
  s_cmp_eq_u32 s3, 0
  s_cbranch_scc1 gated_mix__softmax_full_mha__sliding_local_dilated__prompt_kernel_fbe
  s_waitcnt vmcnt(6)
  s_mov_b64 exec, 1
  v_mov_b32 v8, 98308
  v_mov_b32 v9, 1
  ds_add_rtn_u32 v10, v8, v9
  s_waitcnt lgkmcnt(0)
  s_mov_b64 exec, -1
  v_readfirstlane_b32 s9, v10
  s_nop 3
  s_cmp_lg_u32 s9, 3
  s_cbranch_scc1 gated_mix__softmax_full_mha__sliding_local_dilated__prompt_kernel_fbe
  s_lshl_b32 s9, s2, 2
  s_add_u32 s8, s9, 26247168
  v_lshlrev_b32 v9, 10, v2
  v_mov_b32 v8, s66
  s_mov_b32 exec_hi, 0
  buffer_store_dword v8, v9, s[16:19], s8 offen sc1
  s_mov_b64 exec, -1
  s_mov_b32 s3, 2
gated_mix__softmax_full_mha__sliding_local_dilated__prompt_kernel_fbe:
  v_exp_f32 v72, v72
  v_exp_f32 v73, v73
  v_exp_f32 v74, v74
  v_exp_f32 v75, v75
  v_cvt_pk_bf16_f32 v56, v72, v73
  v_cvt_pk_bf16_f32 v57, v74, v75
  v_mfma_f32_32x32x16_bf16 v[88:103], v[34:37], v[20:23], v[88:103]
  ds_read_b128 v[28:31], v3 offset:11264
  v_exp_f32 v76, v76
  v_exp_f32 v77, v77
  v_exp_f32 v78, v78
  v_exp_f32 v79, v79
  v_cvt_pk_bf16_f32 v58, v76, v77
  v_cvt_pk_bf16_f32 v59, v78, v79
  v_mfma_f32_32x32x16_bf16 v[120:135], v[44:47], v[68:71], v[120:135]
  v_exp_f32 v80, v80
  v_exp_f32 v81, v81
  v_exp_f32 v82, v82
  v_exp_f32 v83, v83
  v_cvt_pk_bf16_f32 v60, v80, v81
  v_cvt_pk_bf16_f32 v61, v82, v83
  v_mfma_f32_32x32x16_bf16 v[104:119], v[48:51], v[56:59], v[104:119]
  v_exp_f32 v84, v84
  v_exp_f32 v85, v85
  v_exp_f32 v86, v86
  v_exp_f32 v87, v87
  v_cvt_pk_bf16_f32 v62, v84, v85
  v_cvt_pk_bf16_f32 v63, v86, v87
  s_waitcnt lgkmcnt(0)
  v_mfma_f32_32x32x8bf16_1k v[72:87], v[32:33], v[24:25], 0
  ds_read_b128 v[40:43], v5 offset:11264
  v_exp_f32 v88, v88
  v_exp_f32 v89, v89
  v_exp_f32 v90, v90
  v_exp_f32 v91, v91
  v_cvt_pk_bf16_f32 v64, v88, v89
  v_cvt_pk_bf16_f32 v65, v90, v91
  v_mfma_f32_32x32x16_bf16 v[72:87], v[28:31], v[16:19], v[72:87]
  ds_read_b128 v[44:47], v5 offset:12032
  v_exp_f32 v92, v92
  v_exp_f32 v93, v93
  v_exp_f32 v94, v94
  v_exp_f32 v95, v95
  v_cvt_pk_bf16_f32 v66, v92, v93
  v_cvt_pk_bf16_f32 v67, v94, v95
  v_mfma_f32_32x32x16_bf16 v[104:119], v[52:55], v[60:63], v[104:119]
  v_exp_f32 v96, v96
  v_exp_f32 v97, v97
  v_exp_f32 v98, v98
  v_exp_f32 v99, v99
  v_cvt_pk_bf16_f32 v68, v96, v97
  v_cvt_pk_bf16_f32 v69, v98, v99
  v_mfma_f32_32x32x16_bf16 v[120:135], v[48:51], v[64:67], v[120:135]
  v_exp_f32 v100, v100
  v_exp_f32 v101, v101
  v_exp_f32 v102, v102
  v_exp_f32 v103, v103
  v_cvt_pk_bf16_f32 v70, v100, v101
  v_cvt_pk_bf16_f32 v71, v102, v103
  s_waitcnt lgkmcnt(0)
  v_mfma_f32_32x32x8bf16_1k v[88:103], v[32:33], v[26:27], 0
  ds_read_b64 v[38:39], v4 offset:16896
  v_exp_f32 v72, v72
  v_exp_f32 v73, v73
  v_exp_f32 v74, v74
  v_exp_f32 v75, v75
  v_cvt_pk_bf16_f32 v56, v72, v73
  v_cvt_pk_bf16_f32 v57, v74, v75
  v_mfma_f32_32x32x16_bf16 v[88:103], v[28:31], v[20:23], v[88:103]
  ds_read_b128 v[34:37], v3 offset:16896
  v_exp_f32 v76, v76
  v_exp_f32 v77, v77
  v_exp_f32 v78, v78
  v_exp_f32 v79, v79
  v_cvt_pk_bf16_f32 v58, v76, v77
  v_cvt_pk_bf16_f32 v59, v78, v79
  v_mfma_f32_32x32x16_bf16 v[120:135], v[52:55], v[68:71], v[120:135]
  v_exp_f32 v80, v80
  v_exp_f32 v81, v81
  v_exp_f32 v82, v82
  v_exp_f32 v83, v83
  v_cvt_pk_bf16_f32 v60, v80, v81
  v_cvt_pk_bf16_f32 v61, v82, v83
  v_mfma_f32_32x32x16_bf16 v[104:119], v[40:43], v[56:59], v[104:119]
  v_exp_f32 v84, v84
  v_exp_f32 v85, v85
  v_exp_f32 v86, v86
  v_exp_f32 v87, v87
  v_cvt_pk_bf16_f32 v62, v84, v85
  v_cvt_pk_bf16_f32 v63, v86, v87
  s_waitcnt lgkmcnt(0)
  v_mfma_f32_32x32x8bf16_1k v[72:87], v[38:39], v[24:25], 0
  ds_read_b128 v[48:51], v5 offset:16896
  v_exp_f32 v88, v88
  v_exp_f32 v89, v89
  v_exp_f32 v90, v90
  v_exp_f32 v91, v91
  v_cvt_pk_bf16_f32 v64, v88, v89
  v_cvt_pk_bf16_f32 v65, v90, v91
  v_mfma_f32_32x32x16_bf16 v[72:87], v[34:37], v[16:19], v[72:87]
  ds_read_b128 v[52:55], v5 offset:17664
  v_exp_f32 v92, v92
  v_exp_f32 v93, v93
  v_exp_f32 v94, v94
  v_exp_f32 v95, v95
  v_cvt_pk_bf16_f32 v66, v92, v93
  v_cvt_pk_bf16_f32 v67, v94, v95
  v_mfma_f32_32x32x16_bf16 v[104:119], v[44:47], v[60:63], v[104:119]
  v_exp_f32 v96, v96
  v_exp_f32 v97, v97
  v_exp_f32 v98, v98
  v_exp_f32 v99, v99
  v_cvt_pk_bf16_f32 v68, v96, v97
  v_cvt_pk_bf16_f32 v69, v98, v99
  v_mfma_f32_32x32x16_bf16 v[120:135], v[40:43], v[64:67], v[120:135]
  v_exp_f32 v100, v100
  v_exp_f32 v101, v101
  v_exp_f32 v102, v102
  v_exp_f32 v103, v103
  v_cvt_pk_bf16_f32 v70, v100, v101
  v_cvt_pk_bf16_f32 v71, v102, v103
  s_cmp_eq_u32 s3, 2
  s_cbranch_scc1 gated_mix__softmax_full_mha__sliding_local_dilated__prompt_kernel_z0a
  s_waitcnt vmcnt(0) lgkmcnt(0)
  s_branch gated_mix__softmax_full_mha__sliding_local_dilated__prompt_kernel_z0b
gated_mix__softmax_full_mha__sliding_local_dilated__prompt_kernel_z0a:
  s_waitcnt vmcnt(1) lgkmcnt(0)
gated_mix__softmax_full_mha__sliding_local_dilated__prompt_kernel_z0b:
  s_barrier
  v_mfma_f32_32x32x8bf16_1k v[88:103], v[38:39], v[26:27], 0
  ds_read_b64 v[32:33], v4 offset:45056
  s_add_u32 m0, s28, 0
  s_add_u32 s30, s26, 90112
  buffer_load_dwordx4 v6, s[16:19], s30 offen sc1 lds
  v_exp_f32 v72, v72
  v_exp_f32 v73, v73
  v_exp_f32 v74, v74
  v_exp_f32 v75, v75
  v_cvt_pk_bf16_f32 v56, v72, v73
  v_cvt_pk_bf16_f32 v57, v74, v75
  v_mfma_f32_32x32x16_bf16 v[88:103], v[34:37], v[20:23], v[88:103]
  ds_read_b128 v[28:31], v3 offset:45056
  s_add_u32 m0, s28, 8192
  s_add_u32 s30, s26, 98304
  buffer_load_dwordx4 v6, s[16:19], s30 offen sc1 lds
  v_exp_f32 v76, v76
  v_exp_f32 v77, v77
  v_exp_f32 v78, v78
  v_exp_f32 v79, v79
  v_cvt_pk_bf16_f32 v58, v76, v77
  v_cvt_pk_bf16_f32 v59, v78, v79
  v_mfma_f32_32x32x16_bf16 v[120:135], v[44:47], v[68:71], v[120:135]
  s_add_u32 m0, s28, 16384
  s_add_u32 s30, s26, 106496
  buffer_load_dwordx4 v6, s[16:19], s30 offen sc1 lds
  v_exp_f32 v80, v80
  v_exp_f32 v81, v81
  v_exp_f32 v82, v82
  v_exp_f32 v83, v83
  v_cvt_pk_bf16_f32 v60, v80, v81
  v_cvt_pk_bf16_f32 v61, v82, v83
  v_mfma_f32_32x32x16_bf16 v[104:119], v[48:51], v[56:59], v[104:119]
  s_add_u32 m0, s28, 24576
  s_add_u32 s30, s26, 114688
  buffer_load_dwordx4 v6, s[16:19], s30 offen sc1 lds
  v_exp_f32 v84, v84
  v_exp_f32 v85, v85
  v_exp_f32 v86, v86
  v_exp_f32 v87, v87
  v_cvt_pk_bf16_f32 v62, v84, v85
  v_cvt_pk_bf16_f32 v63, v86, v87
  s_waitcnt lgkmcnt(0)
  v_mfma_f32_32x32x8bf16_1k v[72:87], v[32:33], v[24:25], 0
  ds_read_b128 v[40:43], v5 offset:45056
  s_add_u32 m0, s28, 32768
  s_add_u32 s30, s26, 122880
  buffer_load_dwordx4 v6, s[16:19], s30 offen sc1 lds
  s_lshr_b32 s90, s2, 3
  s_lshl_b32 s90, s90, 3
  s_add_u32 s90, s90, s20
  v_lshlrev_b32 v229, 8, v2
  v_add_u32 v229, s90, v229
  v_mul_u32_u24 v230, 52429, v229
  v_lshrrev_b32 v230, 18, v230
  v_mul_u32_u24 v231, 5, v230
  v_sub_u32 v231, v229, v231
  v_lshlrev_b32 v231, 7, v231
  v_mul_u32_u24 v230, 1280, v230
  s_and_b32 s90, s2, 1
  s_mul_i32 s90, s90, 640
  v_add_u32 v230, v230, v231
  s_mov_b64 exec, 0x1fff
  buffer_load_dword v231, v230, s[44:47], s90 offen
  buffer_load_dword v229, v230, s[60:63], s90 offen
  s_mov_b64 exec, -1
  v_exp_f32 v88, v88
  v_exp_f32 v89, v89
  v_exp_f32 v90, v90
  v_exp_f32 v91, v91
  v_cvt_pk_bf16_f32 v64, v88, v89
  v_cvt_pk_bf16_f32 v65, v90, v91
  v_mfma_f32_32x32x16_bf16 v[72:87], v[28:31], v[16:19], v[72:87]
  ds_read_b128 v[44:47], v5 offset:45824
  s_add_u32 m0, s38, 0
  s_add_u32 s30, s26, 90112
  s_mov_b32 exec_hi, 0
  buffer_load_dwordx4 v7, s[16:19], s30 offen sc1 lds
  s_mov_b64 exec, -1
  v_exp_f32 v92, v92
  v_exp_f32 v93, v93
  v_exp_f32 v94, v94
  v_exp_f32 v95, v95
  v_cvt_pk_bf16_f32 v66, v92, v93
  v_cvt_pk_bf16_f32 v67, v94, v95
  v_mfma_f32_32x32x16_bf16 v[104:119], v[52:55], v[60:63], v[104:119]
  v_exp_f32 v96, v96
  v_exp_f32 v97, v97
  v_exp_f32 v98, v98
  v_exp_f32 v99, v99
  v_cvt_pk_bf16_f32 v68, v96, v97
  v_cvt_pk_bf16_f32 v69, v98, v99
  v_mfma_f32_32x32x16_bf16 v[120:135], v[48:51], v[64:67], v[120:135]
  v_exp_f32 v100, v100
  v_exp_f32 v101, v101
  v_exp_f32 v102, v102
  v_exp_f32 v103, v103
  v_cvt_pk_bf16_f32 v70, v100, v101
  v_cvt_pk_bf16_f32 v71, v102, v103
  s_waitcnt lgkmcnt(0)
  v_mfma_f32_32x32x8bf16_1k v[88:103], v[32:33], v[26:27], 0
  ds_read_b64 v[38:39], v4 offset:50688
  v_exp_f32 v72, v72
  v_exp_f32 v73, v73
  v_exp_f32 v74, v74
  v_exp_f32 v75, v75
  v_cvt_pk_bf16_f32 v56, v72, v73
  v_cvt_pk_bf16_f32 v57, v74, v75
  v_mfma_f32_32x32x16_bf16 v[88:103], v[28:31], v[20:23], v[88:103]
  ds_read_b128 v[34:37], v3 offset:50688
  v_exp_f32 v76, v76
  v_exp_f32 v77, v77
  v_exp_f32 v78, v78
  v_exp_f32 v79, v79
  v_cvt_pk_bf16_f32 v58, v76, v77
  v_cvt_pk_bf16_f32 v59, v78, v79
  v_mfma_f32_32x32x16_bf16 v[120:135], v[52:55], v[68:71], v[120:135]
  v_exp_f32 v80, v80
  v_exp_f32 v81, v81
  v_exp_f32 v82, v82
  v_exp_f32 v83, v83
  v_cvt_pk_bf16_f32 v60, v80, v81
  v_cvt_pk_bf16_f32 v61, v82, v83
  v_mfma_f32_32x32x16_bf16 v[104:119], v[40:43], v[56:59], v[104:119]
  v_exp_f32 v84, v84
  v_exp_f32 v85, v85
  v_exp_f32 v86, v86
  v_exp_f32 v87, v87
  v_cvt_pk_bf16_f32 v62, v84, v85
  v_cvt_pk_bf16_f32 v63, v86, v87
  s_waitcnt lgkmcnt(0)
  v_mfma_f32_32x32x8bf16_1k v[72:87], v[38:39], v[24:25], 0
  ds_read_b128 v[48:51], v5 offset:50688
  v_exp_f32 v88, v88
  v_exp_f32 v89, v89
  v_exp_f32 v90, v90
  v_exp_f32 v91, v91
  v_cvt_pk_bf16_f32 v64, v88, v89
  v_cvt_pk_bf16_f32 v65, v90, v91
  v_mfma_f32_32x32x16_bf16 v[72:87], v[34:37], v[16:19], v[72:87]
  ds_read_b128 v[52:55], v5 offset:51456
  v_exp_f32 v92, v92
  v_exp_f32 v93, v93
  v_exp_f32 v94, v94
  v_exp_f32 v95, v95
  v_cvt_pk_bf16_f32 v66, v92, v93
  v_cvt_pk_bf16_f32 v67, v94, v95
  v_mfma_f32_32x32x16_bf16 v[104:119], v[44:47], v[60:63], v[104:119]
  v_exp_f32 v96, v96
  v_exp_f32 v97, v97
  v_exp_f32 v98, v98
  v_exp_f32 v99, v99
  v_cvt_pk_bf16_f32 v68, v96, v97
  v_cvt_pk_bf16_f32 v69, v98, v99
  v_mfma_f32_32x32x16_bf16 v[120:135], v[40:43], v[64:67], v[120:135]
  v_exp_f32 v100, v100
  v_exp_f32 v101, v101
  v_exp_f32 v102, v102
  v_exp_f32 v103, v103
  v_cvt_pk_bf16_f32 v70, v100, v101
  v_cvt_pk_bf16_f32 v71, v102, v103
  s_waitcnt lgkmcnt(0)
  v_mfma_f32_32x32x8bf16_1k v[88:103], v[38:39], v[26:27], 0
  ds_read_b64 v[32:33], v4 offset:56320
  s_cmp_lg_u32 s20, 0
  s_cbranch_scc1 gated_mix__softmax_full_mha__sliding_local_dilated__prompt_kernel_z0
  v_lshlrev_b32 v236, 4, v2
  s_and_b32 s91, s2, 31
  s_lshl_b32 s91, s91, 10
  s_add_u32 s91, s91, 26247168
  buffer_load_dwordx4 v[232:235], v236, s[16:19], s91 offen sc1
gated_mix__softmax_full_mha__sliding_local_dilated__prompt_kernel_z0:
  v_exp_f32 v72, v72
  v_exp_f32 v73, v73
  v_exp_f32 v74, v74
  v_exp_f32 v75, v75
  v_cvt_pk_bf16_f32 v56, v72, v73
  v_cvt_pk_bf16_f32 v57, v74, v75
  v_mfma_f32_32x32x16_bf16 v[88:103], v[34:37], v[20:23], v[88:103]
  ds_read_b128 v[28:31], v3 offset:56320
  v_exp_f32 v76, v76
  v_exp_f32 v77, v77
  v_exp_f32 v78, v78
  v_exp_f32 v79, v79
  v_cvt_pk_bf16_f32 v58, v76, v77
  v_cvt_pk_bf16_f32 v59, v78, v79
  v_mfma_f32_32x32x16_bf16 v[120:135], v[44:47], v[68:71], v[120:135]
  v_exp_f32 v80, v80
  v_exp_f32 v81, v81
  v_exp_f32 v82, v82
  v_exp_f32 v83, v83
  v_cvt_pk_bf16_f32 v60, v80, v81
  v_cvt_pk_bf16_f32 v61, v82, v83
  v_mfma_f32_32x32x16_bf16 v[104:119], v[48:51], v[56:59], v[104:119]
  v_exp_f32 v84, v84
  v_exp_f32 v85, v85
  v_exp_f32 v86, v86
  v_exp_f32 v87, v87
  v_cvt_pk_bf16_f32 v62, v84, v85
  v_cvt_pk_bf16_f32 v63, v86, v87
  s_waitcnt lgkmcnt(0)
  v_mfma_f32_32x32x8bf16_1k v[72:87], v[32:33], v[24:25], 0
  ds_read_b128 v[40:43], v5 offset:56320
  v_exp_f32 v88, v88
  v_exp_f32 v89, v89
  v_exp_f32 v90, v90
  v_exp_f32 v91, v91
  v_cvt_pk_bf16_f32 v64, v88, v89
  v_cvt_pk_bf16_f32 v65, v90, v91
  v_mfma_f32_32x32x16_bf16 v[72:87], v[28:31], v[16:19], v[72:87]
  ds_read_b128 v[44:47], v5 offset:57088
  v_exp_f32 v92, v92
  v_exp_f32 v93, v93
  v_exp_f32 v94, v94
  v_exp_f32 v95, v95
  v_cvt_pk_bf16_f32 v66, v92, v93
  v_cvt_pk_bf16_f32 v67, v94, v95
  v_mfma_f32_32x32x16_bf16 v[104:119], v[52:55], v[60:63], v[104:119]
  v_exp_f32 v96, v96
  v_exp_f32 v97, v97
  v_exp_f32 v98, v98
  v_exp_f32 v99, v99
  v_cvt_pk_bf16_f32 v68, v96, v97
  v_cvt_pk_bf16_f32 v69, v98, v99
  v_mfma_f32_32x32x16_bf16 v[120:135], v[48:51], v[64:67], v[120:135]
  v_exp_f32 v100, v100
  v_exp_f32 v101, v101
  v_exp_f32 v102, v102
  v_exp_f32 v103, v103
  v_cvt_pk_bf16_f32 v70, v100, v101
  v_cvt_pk_bf16_f32 v71, v102, v103
  s_waitcnt lgkmcnt(0)
  v_mfma_f32_32x32x8bf16_1k v[88:103], v[32:33], v[26:27], 0
  ds_read_b64 v[38:39], v4 offset:61952
  v_exp_f32 v72, v72
  v_exp_f32 v73, v73
  v_exp_f32 v74, v74
  v_exp_f32 v75, v75
  v_cvt_pk_bf16_f32 v56, v72, v73
  v_cvt_pk_bf16_f32 v57, v74, v75
  v_mfma_f32_32x32x16_bf16 v[88:103], v[28:31], v[20:23], v[88:103]
  ds_read_b128 v[34:37], v3 offset:61952
  v_exp_f32 v76, v76
  v_exp_f32 v77, v77
  v_exp_f32 v78, v78
  v_exp_f32 v79, v79
  v_cvt_pk_bf16_f32 v58, v76, v77
  v_cvt_pk_bf16_f32 v59, v78, v79
  v_mfma_f32_32x32x16_bf16 v[120:135], v[52:55], v[68:71], v[120:135]
  v_exp_f32 v80, v80
  v_exp_f32 v81, v81
  v_exp_f32 v82, v82
  v_exp_f32 v83, v83
  v_cvt_pk_bf16_f32 v60, v80, v81
  v_cvt_pk_bf16_f32 v61, v82, v83
  v_mfma_f32_32x32x16_bf16 v[104:119], v[40:43], v[56:59], v[104:119]
  v_exp_f32 v84, v84
  v_exp_f32 v85, v85
  v_exp_f32 v86, v86
  v_exp_f32 v87, v87
  v_cvt_pk_bf16_f32 v62, v84, v85
  v_cvt_pk_bf16_f32 v63, v86, v87
  s_waitcnt lgkmcnt(0)
  v_mfma_f32_32x32x8bf16_1k v[72:87], v[38:39], v[24:25], 0
  ds_read_b128 v[48:51], v5 offset:61952
  v_exp_f32 v88, v88
  v_exp_f32 v89, v89
  v_exp_f32 v90, v90
  v_exp_f32 v91, v91
  v_cvt_pk_bf16_f32 v64, v88, v89
  v_cvt_pk_bf16_f32 v65, v90, v91
  v_mfma_f32_32x32x16_bf16 v[72:87], v[34:37], v[16:19], v[72:87]
  ds_read_b128 v[52:55], v5 offset:62720
  v_exp_f32 v92, v92
  v_exp_f32 v93, v93
  v_exp_f32 v94, v94
  v_exp_f32 v95, v95
  v_cvt_pk_bf16_f32 v66, v92, v93
  v_cvt_pk_bf16_f32 v67, v94, v95
  v_mfma_f32_32x32x16_bf16 v[104:119], v[44:47], v[60:63], v[104:119]
  v_exp_f32 v96, v96
  v_exp_f32 v97, v97
  v_exp_f32 v98, v98
  v_exp_f32 v99, v99
  v_cvt_pk_bf16_f32 v68, v96, v97
  v_cvt_pk_bf16_f32 v69, v98, v99
  v_mfma_f32_32x32x16_bf16 v[120:135], v[40:43], v[64:67], v[120:135]
  v_exp_f32 v100, v100
  v_exp_f32 v101, v101
  v_exp_f32 v102, v102
  v_exp_f32 v103, v103
  v_cvt_pk_bf16_f32 v70, v100, v101
  v_cvt_pk_bf16_f32 v71, v102, v103
  s_waitcnt vmcnt(0) lgkmcnt(0)
  s_cmp_lg_u32 s20, 0
  s_cbranch_scc1 gated_mix__softmax_full_mha__sliding_local_dilated__prompt_kernel_pb1
  v_xor_b32 v232, s66, v232
  v_xor_b32 v233, s66, v233
  v_xor_b32 v234, s66, v234
  v_xor_b32 v235, s66, v235
  v_or3_b32 v232, v232, v233, v234
  v_or_b32 v232, v232, v235
  v_cmp_ne_u32 vcc, 0, v232
  s_nop 4
  s_cbranch_vccz gated_mix__softmax_full_mha__sliding_local_dilated__prompt_kernel_pfb_early
  v_lshlrev_b32 v240, 4, v2
  s_and_b32 s91, s2, 31
  s_lshl_b32 s91, s91, 10
  s_add_u32 s91, s91, 26247168
  s_mov_b32 s90, 200000
gated_mix__softmax_full_mha__sliding_local_dilated__prompt_kernel_pfb:
  buffer_load_dwordx4 v[232:235], v240, s[16:19], s91 offen sc1
  s_waitcnt vmcnt(0)
  v_xor_b32 v232, s66, v232
  v_xor_b32 v233, s66, v233
  v_xor_b32 v234, s66, v234
  v_xor_b32 v235, s66, v235
  v_or3_b32 v232, v232, v233, v234
  v_or_b32 v232, v232, v235
  v_cmp_ne_u32 vcc, 0, v232
  s_nop 4
  s_cbranch_vccz gated_mix__softmax_full_mha__sliding_local_dilated__prompt_kernel_pfb_ok
  s_sub_u32 s90, s90, 1
  s_cmp_eq_u32 s90, 0
  s_cbranch_scc1 gated_mix__softmax_full_mha__sliding_local_dilated__prompt_kernel_pfb_ok
  s_sleep 1
  s_branch gated_mix__softmax_full_mha__sliding_local_dilated__prompt_kernel_pfb
gated_mix__softmax_full_mha__sliding_local_dilated__prompt_kernel_pfb_ok:
gated_mix__softmax_full_mha__sliding_local_dilated__prompt_kernel_pfb_early:
gated_mix__softmax_full_mha__sliding_local_dilated__prompt_kernel_pb1:
  s_barrier
  v_mfma_f32_32x32x8bf16_1k v[88:103], v[38:39], v[26:27], 0
  ds_read_b64 v[32:33], v4 offset:0
  s_add_u32 m0, s28, 45056
  s_add_u32 s30, s26, 135168
  buffer_load_dwordx4 v6, s[16:19], s30 offen sc1 lds
  v_exp_f32 v72, v72
  v_exp_f32 v73, v73
  v_exp_f32 v74, v74
  v_exp_f32 v75, v75
  v_cvt_pk_bf16_f32 v56, v72, v73
  v_cvt_pk_bf16_f32 v57, v74, v75
  v_mfma_f32_32x32x16_bf16 v[88:103], v[34:37], v[20:23], v[88:103]
  ds_read_b128 v[28:31], v3 offset:0
  s_add_u32 m0, s28, 53248
  s_add_u32 s30, s26, 143360
  buffer_load_dwordx4 v6, s[16:19], s30 offen sc1 lds
  v_exp_f32 v76, v76
  v_exp_f32 v77, v77
  v_exp_f32 v78, v78
  v_exp_f32 v79, v79
  v_cvt_pk_bf16_f32 v58, v76, v77
  v_cvt_pk_bf16_f32 v59, v78, v79
  v_mfma_f32_32x32x16_bf16 v[120:135], v[44:47], v[68:71], v[120:135]
  s_add_u32 m0, s28, 61440
  s_add_u32 s30, s26, 151552
  buffer_load_dwordx4 v6, s[16:19], s30 offen sc1 lds
  v_exp_f32 v80, v80
  v_exp_f32 v81, v81
  v_exp_f32 v82, v82
  v_exp_f32 v83, v83
  v_cvt_pk_bf16_f32 v60, v80, v81
  v_cvt_pk_bf16_f32 v61, v82, v83
  v_mfma_f32_32x32x16_bf16 v[104:119], v[48:51], v[56:59], v[104:119]
  s_add_u32 m0, s28, 69632
  s_add_u32 s30, s26, 159744
  buffer_load_dwordx4 v6, s[16:19], s30 offen sc1 lds
  v_exp_f32 v84, v84
  v_exp_f32 v85, v85
  v_exp_f32 v86, v86
  v_exp_f32 v87, v87
  v_cvt_pk_bf16_f32 v62, v84, v85
  v_cvt_pk_bf16_f32 v63, v86, v87
  s_waitcnt lgkmcnt(0)
  v_mfma_f32_32x32x8bf16_1k v[72:87], v[32:33], v[24:25], 0
  ds_read_b128 v[40:43], v5 offset:0
  s_add_u32 m0, s28, 77824
  s_add_u32 s30, s26, 167936
  buffer_load_dwordx4 v6, s[16:19], s30 offen sc1 lds
  v_exp_f32 v88, v88
  v_exp_f32 v89, v89
  v_exp_f32 v90, v90
  v_exp_f32 v91, v91
  v_cvt_pk_bf16_f32 v64, v88, v89
  v_cvt_pk_bf16_f32 v65, v90, v91
  v_mfma_f32_32x32x16_bf16 v[72:87], v[28:31], v[16:19], v[72:87]
  ds_read_b128 v[44:47], v5 offset:768
  s_add_u32 m0, s38, 45056
  s_add_u32 s30, s26, 135168
  s_mov_b32 exec_hi, 0
  buffer_load_dwordx4 v7, s[16:19], s30 offen sc1 lds
  s_mov_b64 exec, -1
  v_exp_f32 v92, v92
  v_exp_f32 v93, v93
  v_exp_f32 v94, v94
  v_exp_f32 v95, v95
  v_cvt_pk_bf16_f32 v66, v92, v93
  v_cvt_pk_bf16_f32 v67, v94, v95
  v_mfma_f32_32x32x16_bf16 v[104:119], v[52:55], v[60:63], v[104:119]
  v_exp_f32 v96, v96
  v_exp_f32 v97, v97
  v_exp_f32 v98, v98
  v_exp_f32 v99, v99
  v_cvt_pk_bf16_f32 v68, v96, v97
  v_cvt_pk_bf16_f32 v69, v98, v99
  v_mfma_f32_32x32x16_bf16 v[120:135], v[48:51], v[64:67], v[120:135]
  v_exp_f32 v100, v100
  v_exp_f32 v101, v101
  v_exp_f32 v102, v102
  v_exp_f32 v103, v103
  v_cvt_pk_bf16_f32 v70, v100, v101
  v_cvt_pk_bf16_f32 v71, v102, v103
  s_waitcnt lgkmcnt(0)
  v_mfma_f32_32x32x8bf16_1k v[88:103], v[32:33], v[26:27], 0
  ds_read_b64 v[38:39], v4 offset:5632
  s_cmp_eq_u32 s25, 1
  s_cselect_b32 s9, 1, 3
  s_sub_u32 s9, s39, s9
  s_cmp_lt_i32 s9, 0
  s_cselect_b32 s9, s39, s9
  s_mul_i32 s10, s21, 360448
  s_add_u32 s10, s10, 12582912
  s_mul_i32 s11, s39, 5632
  s_add_u32 s11, s11, s10
  s_mul_i32 s12, s9, 5632
  s_add_u32 s12, s12, s10
  s_mul_i32 s13, s21, 163840
  s_mul_i32 s15, s39, 2560
  s_add_u32 s15, s15, s13
  s_add_u32 s15, s15, 3145728
  v_exp_f32 v72, v72
  v_exp_f32 v73, v73
  v_exp_f32 v74, v74
  v_exp_f32 v75, v75
  v_cvt_pk_bf16_f32 v56, v72, v73
  v_cvt_pk_bf16_f32 v57, v74, v75
  v_mfma_f32_32x32x16_bf16 v[88:103], v[28:31], v[20:23], v[88:103]
  ds_read_b128 v[34:37], v3 offset:5632
  buffer_load_dwordx4 v[136:139], v244, s[16:19], s15 offen sc1
  v_exp_f32 v76, v76
  v_exp_f32 v77, v77
  v_exp_f32 v78, v78
  v_exp_f32 v79, v79
  v_cvt_pk_bf16_f32 v58, v76, v77
  v_cvt_pk_bf16_f32 v59, v78, v79
  v_mfma_f32_32x32x16_bf16 v[120:135], v[52:55], v[68:71], v[120:135]
  buffer_load_dwordx2 v[140:141], v245, s[16:19], s15 offen sc1
  v_exp_f32 v80, v80
  v_exp_f32 v81, v81
  v_exp_f32 v82, v82
  v_exp_f32 v83, v83
  v_cvt_pk_bf16_f32 v60, v80, v81
  v_cvt_pk_bf16_f32 v61, v82, v83
  v_mfma_f32_32x32x16_bf16 v[104:119], v[40:43], v[56:59], v[104:119]
  buffer_load_dwordx4 v[142:145], v244, s[16:19], s11 offen sc1
  v_exp_f32 v84, v84
  v_exp_f32 v85, v85
  v_exp_f32 v86, v86
  v_exp_f32 v87, v87
  v_cvt_pk_bf16_f32 v62, v84, v85
  v_cvt_pk_bf16_f32 v63, v86, v87
  s_waitcnt lgkmcnt(0)
  v_mfma_f32_32x32x8bf16_1k v[72:87], v[38:39], v[24:25], 0
  ds_read_b128 v[48:51], v5 offset:5632
  buffer_load_dwordx2 v[146:147], v245, s[16:19], s11 offen sc1
  v_exp_f32 v88, v88
  v_exp_f32 v89, v89
  v_exp_f32 v90, v90
  v_exp_f32 v91, v91
  v_cvt_pk_bf16_f32 v64, v88, v89
  v_cvt_pk_bf16_f32 v65, v90, v91
  v_mfma_f32_32x32x16_bf16 v[72:87], v[34:37], v[16:19], v[72:87]
  ds_read_b128 v[52:55], v5 offset:6400
  buffer_load_dwordx4 v[148:151], v244, s[16:19], s12 offen sc1
  v_exp_f32 v92, v92
  v_exp_f32 v93, v93
  v_exp_f32 v94, v94
  v_exp_f32 v95, v95
  v_cvt_pk_bf16_f32 v66, v92, v93
  v_cvt_pk_bf16_f32 v67, v94, v95
  v_mfma_f32_32x32x16_bf16 v[104:119], v[44:47], v[60:63], v[104:119]
  buffer_load_dwordx2 v[152:153], v245, s[16:19], s12 offen sc1
  v_exp_f32 v96, v96
  v_exp_f32 v97, v97
  v_exp_f32 v98, v98
  v_exp_f32 v99, v99
  v_cvt_pk_bf16_f32 v68, v96, v97
  v_cvt_pk_bf16_f32 v69, v98, v99
  v_mfma_f32_32x32x16_bf16 v[120:135], v[40:43], v[64:67], v[120:135]
  buffer_load_dwordx4 v[154:157], v0, s[16:19], s11 offen sc1
  v_exp_f32 v100, v100
  v_exp_f32 v101, v101
  v_exp_f32 v102, v102
  v_exp_f32 v103, v103
  v_cvt_pk_bf16_f32 v70, v100, v101
  v_cvt_pk_bf16_f32 v71, v102, v103
  s_waitcnt lgkmcnt(0)
  v_mfma_f32_32x32x8bf16_1k v[88:103], v[38:39], v[26:27], 0
  ds_read_b64 v[32:33], v4 offset:11264
  buffer_load_dwordx4 v[158:161], v0, s[16:19], s11 offen offset:768 sc1
  v_exp_f32 v72, v72
  v_exp_f32 v73, v73
  v_exp_f32 v74, v74
  v_exp_f32 v75, v75
  v_cvt_pk_bf16_f32 v56, v72, v73
  v_cvt_pk_bf16_f32 v57, v74, v75
  v_mfma_f32_32x32x16_bf16 v[88:103], v[34:37], v[20:23], v[88:103]
  ds_read_b128 v[28:31], v3 offset:11264
  buffer_load_dwordx4 v[162:165], v0, s[16:19], s12 offen offset:768 sc1
  v_exp_f32 v76, v76
  v_exp_f32 v77, v77
  v_exp_f32 v78, v78
  v_exp_f32 v79, v79
  v_cvt_pk_bf16_f32 v58, v76, v77
  v_cvt_pk_bf16_f32 v59, v78, v79
  v_mfma_f32_32x32x16_bf16 v[120:135], v[44:47], v[68:71], v[120:135]
  buffer_load_dword v216, v216, s[16:19], 0 offen sc1
  v_exp_f32 v80, v80
  v_exp_f32 v81, v81
  v_exp_f32 v82, v82
  v_exp_f32 v83, v83
  v_cvt_pk_bf16_f32 v60, v80, v81
  v_cvt_pk_bf16_f32 v61, v82, v83
  v_mfma_f32_32x32x16_bf16 v[104:119], v[48:51], v[56:59], v[104:119]
  buffer_load_dword v227, v227, s[16:19], 0 offen sc1
  v_exp_f32 v84, v84
  v_exp_f32 v85, v85
  v_exp_f32 v86, v86
  v_exp_f32 v87, v87
  v_cvt_pk_bf16_f32 v62, v84, v85
  v_cvt_pk_bf16_f32 v63, v86, v87
  s_waitcnt lgkmcnt(0)
  v_mfma_f32_32x32x8bf16_1k v[72:87], v[32:33], v[24:25], 0
  ds_read_b128 v[40:43], v5 offset:11264
  v_exp_f32 v88, v88
  v_exp_f32 v89, v89
  v_exp_f32 v90, v90
  v_exp_f32 v91, v91
  v_cvt_pk_bf16_f32 v64, v88, v89
  v_cvt_pk_bf16_f32 v65, v90, v91
  v_mfma_f32_32x32x16_bf16 v[72:87], v[28:31], v[16:19], v[72:87]
  ds_read_b128 v[44:47], v5 offset:12032
  v_exp_f32 v92, v92
  v_exp_f32 v93, v93
  v_exp_f32 v94, v94
  v_exp_f32 v95, v95
  v_cvt_pk_bf16_f32 v66, v92, v93
  v_cvt_pk_bf16_f32 v67, v94, v95
  v_mfma_f32_32x32x16_bf16 v[104:119], v[52:55], v[60:63], v[104:119]
  v_exp_f32 v96, v96
  v_exp_f32 v97, v97
  v_exp_f32 v98, v98
  v_exp_f32 v99, v99
  v_cvt_pk_bf16_f32 v68, v96, v97
  v_cvt_pk_bf16_f32 v69, v98, v99
  v_mfma_f32_32x32x16_bf16 v[120:135], v[48:51], v[64:67], v[120:135]
  v_exp_f32 v100, v100
  v_exp_f32 v101, v101
  v_exp_f32 v102, v102
  v_exp_f32 v103, v103
  v_cvt_pk_bf16_f32 v70, v100, v101
  v_cvt_pk_bf16_f32 v71, v102, v103
  s_waitcnt lgkmcnt(0)
  v_mfma_f32_32x32x8bf16_1k v[88:103], v[32:33], v[26:27], 0
  ds_read_b64 v[38:39], v4 offset:16896
  v_exp_f32 v72, v72
  v_exp_f32 v73, v73
  v_exp_f32 v74, v74
  v_exp_f32 v75, v75
  v_cvt_pk_bf16_f32 v56, v72, v73
  v_cvt_pk_bf16_f32 v57, v74, v75
  v_mfma_f32_32x32x16_bf16 v[88:103], v[28:31], v[20:23], v[88:103]
  ds_read_b128 v[34:37], v3 offset:16896
  v_exp_f32 v76, v76
  v_exp_f32 v77, v77
  v_exp_f32 v78, v78
  v_exp_f32 v79, v79
  v_cvt_pk_bf16_f32 v58, v76, v77
  v_cvt_pk_bf16_f32 v59, v78, v79
  v_mfma_f32_32x32x16_bf16 v[120:135], v[52:55], v[68:71], v[120:135]
  v_exp_f32 v80, v80
  v_exp_f32 v81, v81
  v_exp_f32 v82, v82
  v_exp_f32 v83, v83
  v_cvt_pk_bf16_f32 v60, v80, v81
  v_cvt_pk_bf16_f32 v61, v82, v83
  v_mfma_f32_32x32x16_bf16 v[104:119], v[40:43], v[56:59], v[104:119]
  v_exp_f32 v84, v84
  v_exp_f32 v85, v85
  v_exp_f32 v86, v86
  v_exp_f32 v87, v87
  v_cvt_pk_bf16_f32 v62, v84, v85
  v_cvt_pk_bf16_f32 v63, v86, v87
  s_waitcnt lgkmcnt(0)
  v_mfma_f32_32x32x8bf16_1k v[72:87], v[38:39], v[24:25], 0
  ds_read_b128 v[48:51], v5 offset:16896
  v_exp_f32 v88, v88
  v_exp_f32 v89, v89
  v_exp_f32 v90, v90
  v_exp_f32 v91, v91
  v_cvt_pk_bf16_f32 v64, v88, v89
  v_cvt_pk_bf16_f32 v65, v90, v91
  v_mfma_f32_32x32x16_bf16 v[72:87], v[34:37], v[16:19], v[72:87]
  ds_read_b128 v[52:55], v5 offset:17664
  v_exp_f32 v92, v92
  v_exp_f32 v93, v93
  v_exp_f32 v94, v94
  v_exp_f32 v95, v95
  v_cvt_pk_bf16_f32 v66, v92, v93
  v_cvt_pk_bf16_f32 v67, v94, v95
  v_mfma_f32_32x32x16_bf16 v[104:119], v[44:47], v[60:63], v[104:119]
  v_exp_f32 v96, v96
  v_exp_f32 v97, v97
  v_exp_f32 v98, v98
  v_exp_f32 v99, v99
  v_cvt_pk_bf16_f32 v68, v96, v97
  v_cvt_pk_bf16_f32 v69, v98, v99
  v_mfma_f32_32x32x16_bf16 v[120:135], v[40:43], v[64:67], v[120:135]
  v_exp_f32 v100, v100
  v_exp_f32 v101, v101
  v_exp_f32 v102, v102
  v_exp_f32 v103, v103
  v_cvt_pk_bf16_f32 v70, v100, v101
  v_cvt_pk_bf16_f32 v71, v102, v103
  s_waitcnt vmcnt(0) lgkmcnt(0)
  s_barrier
  v_mfma_f32_32x32x8bf16_1k v[88:103], v[38:39], v[26:27], 0
  ds_read_b64 v[32:33], v4 offset:45056
  s_add_u32 m0, s28, 0
  s_add_u32 s30, s26, 180224
  buffer_load_dwordx4 v6, s[16:19], s30 offen sc1 lds
  v_exp_f32 v72, v72
  v_exp_f32 v73, v73
  v_exp_f32 v74, v74
  v_exp_f32 v75, v75
  v_cvt_pk_bf16_f32 v56, v72, v73
  v_cvt_pk_bf16_f32 v57, v74, v75
  v_mfma_f32_32x32x16_bf16 v[88:103], v[34:37], v[20:23], v[88:103]
  ds_read_b128 v[28:31], v3 offset:45056
  s_add_u32 m0, s28, 8192
  s_add_u32 s30, s26, 188416
  buffer_load_dwordx4 v6, s[16:19], s30 offen sc1 lds
  v_exp_f32 v76, v76
  v_exp_f32 v77, v77
  v_exp_f32 v78, v78
  v_exp_f32 v79, v79
  v_cvt_pk_bf16_f32 v58, v76, v77
  v_cvt_pk_bf16_f32 v59, v78, v79
  v_mfma_f32_32x32x16_bf16 v[120:135], v[44:47], v[68:71], v[120:135]
  s_add_u32 m0, s28, 16384
  s_add_u32 s30, s26, 196608
  buffer_load_dwordx4 v6, s[16:19], s30 offen sc1 lds
  v_exp_f32 v80, v80
  v_exp_f32 v81, v81
  v_exp_f32 v82, v82
  v_exp_f32 v83, v83
  v_cvt_pk_bf16_f32 v60, v80, v81
  v_cvt_pk_bf16_f32 v61, v82, v83
  v_mfma_f32_32x32x16_bf16 v[104:119], v[48:51], v[56:59], v[104:119]
  s_add_u32 m0, s28, 24576
  s_add_u32 s30, s26, 204800
  buffer_load_dwordx4 v6, s[16:19], s30 offen sc1 lds
  v_exp_f32 v84, v84
  v_exp_f32 v85, v85
  v_exp_f32 v86, v86
  v_exp_f32 v87, v87
  v_cvt_pk_bf16_f32 v62, v84, v85
  v_cvt_pk_bf16_f32 v63, v86, v87
  s_waitcnt lgkmcnt(0)
  v_mfma_f32_32x32x8bf16_1k v[72:87], v[32:33], v[24:25], 0
  ds_read_b128 v[40:43], v5 offset:45056
  s_add_u32 m0, s28, 32768
  s_add_u32 s30, s26, 212992
  buffer_load_dwordx4 v6, s[16:19], s30 offen sc1 lds
  v_exp_f32 v88, v88
  v_exp_f32 v89, v89
  v_exp_f32 v90, v90
  v_exp_f32 v91, v91
  v_cvt_pk_bf16_f32 v64, v88, v89
  v_cvt_pk_bf16_f32 v65, v90, v91
  v_mfma_f32_32x32x16_bf16 v[72:87], v[28:31], v[16:19], v[72:87]
  ds_read_b128 v[44:47], v5 offset:45824
  s_add_u32 m0, s38, 0
  s_add_u32 s30, s26, 180224
  s_mov_b32 exec_hi, 0
  buffer_load_dwordx4 v7, s[16:19], s30 offen sc1 lds
  s_mov_b64 exec, -1
  v_exp_f32 v92, v92
  v_exp_f32 v93, v93
  v_exp_f32 v94, v94
  v_exp_f32 v95, v95
  v_cvt_pk_bf16_f32 v66, v92, v93
  v_cvt_pk_bf16_f32 v67, v94, v95
  v_mfma_f32_32x32x16_bf16 v[104:119], v[52:55], v[60:63], v[104:119]
  v_exp_f32 v96, v96
  v_exp_f32 v97, v97
  v_exp_f32 v98, v98
  v_exp_f32 v99, v99
  v_cvt_pk_bf16_f32 v68, v96, v97
  v_cvt_pk_bf16_f32 v69, v98, v99
  v_mfma_f32_32x32x16_bf16 v[120:135], v[48:51], v[64:67], v[120:135]
  v_exp_f32 v100, v100
  v_exp_f32 v101, v101
  v_exp_f32 v102, v102
  v_exp_f32 v103, v103
  v_cvt_pk_bf16_f32 v70, v100, v101
  v_cvt_pk_bf16_f32 v71, v102, v103
  s_waitcnt lgkmcnt(0)
  v_mfma_f32_32x32x8bf16_1k v[88:103], v[32:33], v[26:27], 0
  ds_read_b64 v[38:39], v4 offset:50688
  v_and_b32 v140, v228, v140
  v_and_b32 v141, v228, v141
  v_sub_f32 v227, 1.0, v227
  v_mfma_f32_32x32x16_bf16 v[166:181], v[142:145], v[136:139], v[166:181]
  v_exp_f32 v72, v72
  v_exp_f32 v73, v73
  v_exp_f32 v74, v74
  v_exp_f32 v75, v75
  v_cvt_pk_bf16_f32 v56, v72, v73
  v_cvt_pk_bf16_f32 v57, v74, v75
  v_mfma_f32_32x32x16_bf16 v[88:103], v[28:31], v[20:23], v[88:103]
  ds_read_b128 v[34:37], v3 offset:50688
  v_mfma_f32_32x32x16_bf16 v[182:197], v[148:151], v[136:139], v[182:197]
  v_mfma_f32_32x32x8bf16_1k v[166:181], v[146:147], v[140:141], v[166:181]
  v_mfma_f32_32x32x8bf16_1k v[182:197], v[152:153], v[140:141], v[182:197]
  v_exp_f32 v76, v76
  v_exp_f32 v77, v77
  v_exp_f32 v78, v78
  v_exp_f32 v79, v79
  v_cvt_pk_bf16_f32 v58, v76, v77
  v_cvt_pk_bf16_f32 v59, v78, v79
  v_mfma_f32_32x32x16_bf16 v[120:135], v[52:55], v[68:71], v[120:135]
  v_exp_f32 v80, v80
  v_exp_f32 v81, v81
  v_exp_f32 v82, v82
  v_exp_f32 v83, v83
  v_cvt_pk_bf16_f32 v60, v80, v81
  v_cvt_pk_bf16_f32 v61, v82, v83
  v_mfma_f32_32x32x16_bf16 v[104:119], v[40:43], v[56:59], v[104:119]
  v_exp_f32 v84, v84
  v_exp_f32 v85, v85
  v_exp_f32 v86, v86
  v_exp_f32 v87, v87
  v_cvt_pk_bf16_f32 v62, v84, v85
  v_cvt_pk_bf16_f32 v63, v86, v87
  s_waitcnt lgkmcnt(0)
  v_mfma_f32_32x32x8bf16_1k v[72:87], v[38:39], v[24:25], 0
  ds_read_b128 v[48:51], v5 offset:50688
  v_max3_f32 v232, v166, v167, v168
  v_max3_f32 v232, v232, v169, v170
  v_max3_f32 v232, v232, v171, v172
  v_max3_f32 v232, v232, v173, v174
  v_exp_f32 v88, v88
  v_exp_f32 v89, v89
  v_exp_f32 v90, v90
  v_exp_f32 v91, v91
  v_cvt_pk_bf16_f32 v64, v88, v89
  v_cvt_pk_bf16_f32 v65, v90, v91
  v_mfma_f32_32x32x16_bf16 v[72:87], v[34:37], v[16:19], v[72:87]
  ds_read_b128 v[52:55], v5 offset:51456
  v_max3_f32 v232, v232, v175, v176
  v_max3_f32 v232, v232, v177, v178
  v_max3_f32 v232, v232, v179, v180
  v_max3_f32 v232, v232, v181, v194
  v_exp_f32 v92, v92
  v_exp_f32 v93, v93
  v_exp_f32 v94, v94
  v_exp_f32 v95, v95
  v_cvt_pk_bf16_f32 v66, v92, v93
  v_cvt_pk_bf16_f32 v67, v94, v95
  v_mfma_f32_32x32x16_bf16 v[104:119], v[44:47], v[60:63], v[104:119]
  v_max3_f32 v232, v232, v195, v196
  v_max_f32 v232, v232, v197
  v_mov_b32 v233, v232
  v_exp_f32 v96, v96
  v_exp_f32 v97, v97
  v_exp_f32 v98, v98
  v_exp_f32 v99, v99
  v_cvt_pk_bf16_f32 v68, v96, v97
  v_cvt_pk_bf16_f32 v69, v98, v99
  v_mfma_f32_32x32x16_bf16 v[120:135], v[40:43], v[64:67], v[120:135]
  v_permlane32_swap_b32 v232, v233
  v_exp_f32 v100, v100
  v_exp_f32 v101, v101
  v_exp_f32 v102, v102
  v_exp_f32 v103, v103
  v_cvt_pk_bf16_f32 v70, v100, v101
  v_cvt_pk_bf16_f32 v71, v102, v103
  s_waitcnt lgkmcnt(0)
  v_mfma_f32_32x32x8bf16_1k v[88:103], v[38:39], v[26:27], 0
  ds_read_b64 v[32:33], v4 offset:56320
  v_max_f32 v232, v232, v233
  v_sub_f32 v166, v166, v232
  v_sub_f32 v167, v167, v232
  v_sub_f32 v168, v168, v232
  v_exp_f32 v72, v72
  v_exp_f32 v73, v73
  v_exp_f32 v74, v74
  v_exp_f32 v75, v75
  v_cvt_pk_bf16_f32 v56, v72, v73
  v_cvt_pk_bf16_f32 v57, v74, v75
  v_mfma_f32_32x32x16_bf16 v[88:103], v[34:37], v[20:23], v[88:103]
  ds_read_b128 v[28:31], v3 offset:56320
  v_sub_f32 v169, v169, v232
  v_sub_f32 v170, v170, v232
  v_sub_f32 v171, v171, v232
  v_sub_f32 v172, v172, v232
  v_exp_f32 v76, v76
  v_exp_f32 v77, v77
  v_exp_f32 v78, v78
  v_exp_f32 v79, v79
  v_cvt_pk_bf16_f32 v58, v76, v77
  v_cvt_pk_bf16_f32 v59, v78, v79
  v_mfma_f32_32x32x16_bf16 v[120:135], v[44:47], v[68:71], v[120:135]
  v_sub_f32 v173, v173, v232
  v_sub_f32 v174, v174, v232
  v_sub_f32 v175, v175, v232
  v_sub_f32 v176, v176, v232
  v_exp_f32 v80, v80
  v_exp_f32 v81, v81
  v_exp_f32 v82, v82
  v_exp_f32 v83, v83
  v_cvt_pk_bf16_f32 v60, v80, v81
  v_cvt_pk_bf16_f32 v61, v82, v83
  v_mfma_f32_32x32x16_bf16 v[104:119], v[48:51], v[56:59], v[104:119]
  v_sub_f32 v177, v177, v232
  v_sub_f32 v178, v178, v232
  v_sub_f32 v179, v179, v232
  v_sub_f32 v180, v180, v232
  v_exp_f32 v84, v84
  v_exp_f32 v85, v85
  v_exp_f32 v86, v86
  v_exp_f32 v87, v87
  v_cvt_pk_bf16_f32 v62, v84, v85
  v_cvt_pk_bf16_f32 v63, v86, v87
  s_waitcnt lgkmcnt(0)
  v_mfma_f32_32x32x8bf16_1k v[72:87], v[32:33], v[24:25], 0
  ds_read_b128 v[40:43], v5 offset:56320
  v_sub_f32 v181, v181, v232
  v_sub_f32 v194, v194, v232
  v_sub_f32 v195, v195, v232
  v_sub_f32 v196, v196, v232
  v_exp_f32 v88, v88
  v_exp_f32 v89, v89
  v_exp_f32 v90, v90
  v_exp_f32 v91, v91
  v_cvt_pk_bf16_f32 v64, v88, v89
  v_cvt_pk_bf16_f32 v65, v90, v91
  v_mfma_f32_32x32x16_bf16 v[72:87], v[28:31], v[16:19], v[72:87]
  ds_read_b128 v[44:47], v5 offset:57088
  v_sub_f32 v197, v197, v232
  v_exp_f32 v166, v166
  v_exp_f32 v167, v167
  v_exp_f32 v168, v168
  v_exp_f32 v92, v92
  v_exp_f32 v93, v93
  v_exp_f32 v94, v94
  v_exp_f32 v95, v95
  v_cvt_pk_bf16_f32 v66, v92, v93
  v_cvt_pk_bf16_f32 v67, v94, v95
  v_mfma_f32_32x32x16_bf16 v[104:119], v[52:55], v[60:63], v[104:119]
  v_exp_f32 v169, v169
  v_exp_f32 v170, v170
  v_exp_f32 v171, v171
  v_exp_f32 v172, v172
  v_exp_f32 v96, v96
  v_exp_f32 v97, v97
  v_exp_f32 v98, v98
  v_exp_f32 v99, v99
  v_cvt_pk_bf16_f32 v68, v96, v97
  v_cvt_pk_bf16_f32 v69, v98, v99
  v_mfma_f32_32x32x16_bf16 v[120:135], v[48:51], v[64:67], v[120:135]
  v_exp_f32 v173, v173
  v_exp_f32 v174, v174
  v_exp_f32 v175, v175
  v_exp_f32 v176, v176
  v_exp_f32 v100, v100
  v_exp_f32 v101, v101
  v_exp_f32 v102, v102
  v_exp_f32 v103, v103
  v_cvt_pk_bf16_f32 v70, v100, v101
  v_cvt_pk_bf16_f32 v71, v102, v103
  s_waitcnt lgkmcnt(0)
  v_mfma_f32_32x32x8bf16_1k v[88:103], v[32:33], v[26:27], 0
  ds_read_b64 v[38:39], v4 offset:61952
  v_exp_f32 v177, v177
  v_exp_f32 v178, v178
  v_exp_f32 v179, v179
  v_exp_f32 v180, v180
  v_exp_f32 v72, v72
  v_exp_f32 v73, v73
  v_exp_f32 v74, v74
  v_exp_f32 v75, v75
  v_cvt_pk_bf16_f32 v56, v72, v73
  v_cvt_pk_bf16_f32 v57, v74, v75
  v_mfma_f32_32x32x16_bf16 v[88:103], v[28:31], v[20:23], v[88:103]
  ds_read_b128 v[34:37], v3 offset:61952
  v_exp_f32 v181, v181
  v_exp_f32 v194, v194
  v_exp_f32 v195, v195
  v_exp_f32 v196, v196
  v_exp_f32 v76, v76
  v_exp_f32 v77, v77
  v_exp_f32 v78, v78
  v_exp_f32 v79, v79
  v_cvt_pk_bf16_f32 v58, v76, v77
  v_cvt_pk_bf16_f32 v59, v78, v79
  v_mfma_f32_32x32x16_bf16 v[120:135], v[52:55], v[68:71], v[120:135]
  v_exp_f32 v197, v197
  v_cvt_pk_bf16_f32 v198, v166, v167
  v_cvt_pk_bf16_f32 v199, v168, v169
  v_cvt_pk_bf16_f32 v200, v170, v171
  v_exp_f32 v80, v80
  v_exp_f32 v81, v81
  v_exp_f32 v82, v82
  v_exp_f32 v83, v83
  v_cvt_pk_bf16_f32 v60, v80, v81
  v_cvt_pk_bf16_f32 v61, v82, v83
  v_mfma_f32_32x32x16_bf16 v[104:119], v[40:43], v[56:59], v[104:119]
  v_cvt_pk_bf16_f32 v201, v172, v173
  v_cvt_pk_bf16_f32 v202, v174, v175
  v_cvt_pk_bf16_f32 v203, v176, v177
  v_cvt_pk_bf16_f32 v204, v178, v179
  v_exp_f32 v84, v84
  v_exp_f32 v85, v85
  v_exp_f32 v86, v86
  v_exp_f32 v87, v87
  v_cvt_pk_bf16_f32 v62, v84, v85
  v_cvt_pk_bf16_f32 v63, v86, v87
  s_waitcnt lgkmcnt(0)
  v_mfma_f32_32x32x8bf16_1k v[72:87], v[38:39], v[24:25], 0
  ds_read_b128 v[48:51], v5 offset:61952
  v_cvt_pk_bf16_f32 v205, v180, v181
  v_cvt_pk_bf16_f32 v208, v194, v195
  v_cvt_pk_bf16_f32 v209, v196, v197
  v_exp_f32 v88, v88
  v_exp_f32 v89, v89
  v_exp_f32 v90, v90
  v_exp_f32 v91, v91
  v_cvt_pk_bf16_f32 v64, v88, v89
  v_cvt_pk_bf16_f32 v65, v90, v91
  v_mfma_f32_32x32x16_bf16 v[72:87], v[34:37], v[16:19], v[72:87]
  ds_read_b128 v[52:55], v5 offset:62720
  v_mfma_f32_32x32x16_bf16 v[182:197], v[154:157], v[198:201], 0
  v_mfma_f32_32x32x16_bf16 v[182:197], v[158:161], v[202:205], v[182:197]
  v_mfma_f32_32x32x16_bf16 v[182:197], v[162:165], v[206:209], v[182:197]
  v_exp_f32 v92, v92
  v_exp_f32 v93, v93
  v_exp_f32 v94, v94
  v_exp_f32 v95, v95
  v_cvt_pk_bf16_f32 v66, v92, v93
  v_cvt_pk_bf16_f32 v67, v94, v95
  v_mfma_f32_32x32x16_bf16 v[104:119], v[44:47], v[60:63], v[104:119]
  v_exp_f32 v96, v96
  v_exp_f32 v97, v97
  v_exp_f32 v98, v98
  v_exp_f32 v99, v99
  v_cvt_pk_bf16_f32 v68, v96, v97
  v_cvt_pk_bf16_f32 v69, v98, v99
  v_mfma_f32_32x32x16_bf16 v[120:135], v[40:43], v[64:67], v[120:135]
  v_exp_f32 v100, v100
  v_exp_f32 v101, v101
  v_exp_f32 v102, v102
  v_exp_f32 v103, v103
  v_cvt_pk_bf16_f32 v70, v100, v101
  v_cvt_pk_bf16_f32 v71, v102, v103
  s_waitcnt vmcnt(0) lgkmcnt(0)
  s_barrier
  v_mfma_f32_32x32x8bf16_1k v[88:103], v[38:39], v[26:27], 0
  ds_read_b64 v[32:33], v4 offset:0
  s_add_u32 m0, s28, 45056
  s_add_u32 s30, s26, 225280
  buffer_load_dwordx4 v6, s[16:19], s30 offen sc1 lds
  v_mov_b32 v166, v190
  v_mov_b32 v167, v190
  v_exp_f32 v72, v72
  v_exp_f32 v73, v73
  v_exp_f32 v74, v74
  v_exp_f32 v75, v75
  v_cvt_pk_bf16_f32 v56, v72, v73
  v_cvt_pk_bf16_f32 v57, v74, v75
  v_mfma_f32_32x32x16_bf16 v[88:103], v[34:37], v[20:23], v[88:103]
  ds_read_b128 v[28:31], v3 offset:0
  s_add_u32 m0, s28, 53248
  s_add_u32 s30, s26, 233472
  buffer_load_dwordx4 v6, s[16:19], s30 offen sc1 lds
  v_permlane32_swap_b32 v166, v167
  v_exp_f32 v76, v76
  v_exp_f32 v77, v77
  v_exp_f32 v78, v78
  v_exp_f32 v79, v79
  v_cvt_pk_bf16_f32 v58, v76, v77
  v_cvt_pk_bf16_f32 v59, v78, v79
  v_mfma_f32_32x32x16_bf16 v[120:135], v[44:47], v[68:71], v[120:135]
  s_add_u32 m0, s28, 61440
  s_add_u32 s30, s26, 241664
  buffer_load_dwordx4 v6, s[16:19], s30 offen sc1 lds
  v_rcp_f32 v166, v167
  v_exp_f32 v80, v80
  v_exp_f32 v81, v81
  v_exp_f32 v82, v82
  v_exp_f32 v83, v83
  v_cvt_pk_bf16_f32 v60, v80, v81
  v_cvt_pk_bf16_f32 v61, v82, v83
  v_mfma_f32_32x32x16_bf16 v[104:119], v[48:51], v[56:59], v[104:119]
  s_add_u32 m0, s28, 69632
  s_add_u32 s30, s26, 249856
  buffer_load_dwordx4 v6, s[16:19], s30 offen sc1 lds
  v_mul_f32 v166, v166, v227
  v_mul_f32 v182, v182, v166
  v_mul_f32 v183, v183, v166
  v_mul_f32 v184, v184, v166
  v_exp_f32 v84, v84
  v_exp_f32 v85, v85
  v_exp_f32 v86, v86
  v_exp_f32 v87, v87
  v_cvt_pk_bf16_f32 v62, v84, v85
  v_cvt_pk_bf16_f32 v63, v86, v87
  s_waitcnt lgkmcnt(0)
  v_mfma_f32_32x32x8bf16_1k v[72:87], v[32:33], v[24:25], 0
  ds_read_b128 v[40:43], v5 offset:0
  s_add_u32 m0, s28, 77824
  s_add_u32 s30, s26, 258048
  buffer_load_dwordx4 v6, s[16:19], s30 offen sc1 lds
  v_mul_f32 v185, v185, v166
  v_mul_f32 v186, v186, v166
  v_mul_f32 v187, v187, v166
  v_mul_f32 v188, v188, v166
  v_exp_f32 v88, v88
  v_exp_f32 v89, v89
  v_exp_f32 v90, v90
  v_exp_f32 v91, v91
  v_cvt_pk_bf16_f32 v64, v88, v89
  v_cvt_pk_bf16_f32 v65, v90, v91
  v_mfma_f32_32x32x16_bf16 v[72:87], v[28:31], v[16:19], v[72:87]
  ds_read_b128 v[44:47], v5 offset:768
  s_add_u32 m0, s38, 45056
  s_add_u32 s30, s26, 225280
  s_mov_b32 exec_hi, 0
  buffer_load_dwordx4 v7, s[16:19], s30 offen sc1 lds
  s_mov_b64 exec, -1
  v_mul_f32 v189, v189, v166
  v_mul_f32 v190, v190, v166
  v_mul_f32 v191, v191, v166
  v_mul_f32 v192, v192, v166
  v_exp_f32 v92, v92
  v_exp_f32 v93, v93
  v_exp_f32 v94, v94
  v_exp_f32 v95, v95
  v_cvt_pk_bf16_f32 v66, v92, v93
  v_cvt_pk_bf16_f32 v67, v94, v95
  v_mfma_f32_32x32x16_bf16 v[104:119], v[52:55], v[60:63], v[104:119]
  v_mul_f32 v193, v193, v166
  v_cvt_pk_bf16_f32 v168, v182, v183
  v_cvt_pk_bf16_f32 v169, v184, v185
  v_cvt_pk_bf16_f32 v170, v186, v187
  v_exp_f32 v96, v96
  v_exp_f32 v97, v97
  v_exp_f32 v98, v98
  v_exp_f32 v99, v99
  v_cvt_pk_bf16_f32 v68, v96, v97
  v_cvt_pk_bf16_f32 v69, v98, v99
  v_mfma_f32_32x32x16_bf16 v[120:135], v[48:51], v[64:67], v[120:135]
  v_cvt_pk_bf16_f32 v171, v188, v189
  v_cvt_pk_bf16_f32 v172, v190, v191
  v_cvt_pk_bf16_f32 v173, v192, v193
  s_mov_b32 s9, 2621440
  buffer_store_dwordx4 v[168:171], v14, s[16:19], s9 offen sc1
  v_exp_f32 v100, v100
  v_exp_f32 v101, v101
  v_exp_f32 v102, v102
  v_exp_f32 v103, v103
  v_cvt_pk_bf16_f32 v70, v100, v101
  v_cvt_pk_bf16_f32 v71, v102, v103
  s_waitcnt lgkmcnt(0)
  v_mfma_f32_32x32x8bf16_1k v[88:103], v[32:33], v[26:27], 0
  ds_read_b64 v[38:39], v4 offset:5632
  s_mov_b64 exec, s[32:33]
  buffer_store_dwordx2 v[172:173], v1, s[16:19], s9 offen sc1
  s_mov_b64 exec, -1
  v_exp_f32 v72, v72
  v_exp_f32 v73, v73
  v_exp_f32 v74, v74
  v_exp_f32 v75, v75
  v_cvt_pk_bf16_f32 v56, v72, v73
  v_cvt_pk_bf16_f32 v57, v74, v75
  v_mfma_f32_32x32x16_bf16 v[88:103], v[28:31], v[20:23], v[88:103]
  ds_read_b128 v[34:37], v3 offset:5632
  v_exp_f32 v76, v76
  v_exp_f32 v77, v77
  v_exp_f32 v78, v78
  v_exp_f32 v79, v79
  v_cvt_pk_bf16_f32 v58, v76, v77
  v_cvt_pk_bf16_f32 v59, v78, v79
  v_mfma_f32_32x32x16_bf16 v[120:135], v[52:55], v[68:71], v[120:135]
  v_exp_f32 v80, v80
  v_exp_f32 v81, v81
  v_exp_f32 v82, v82
  v_exp_f32 v83, v83
  v_cvt_pk_bf16_f32 v60, v80, v81
  v_cvt_pk_bf16_f32 v61, v82, v83
  v_mfma_f32_32x32x16_bf16 v[104:119], v[40:43], v[56:59], v[104:119]
  v_exp_f32 v84, v84
  v_exp_f32 v85, v85
  v_exp_f32 v86, v86
  v_exp_f32 v87, v87
  v_cvt_pk_bf16_f32 v62, v84, v85
  v_cvt_pk_bf16_f32 v63, v86, v87
  s_waitcnt lgkmcnt(0)
  v_mfma_f32_32x32x8bf16_1k v[72:87], v[38:39], v[24:25], 0
  ds_read_b128 v[48:51], v5 offset:5632
  v_exp_f32 v88, v88
  v_exp_f32 v89, v89
  v_exp_f32 v90, v90
  v_exp_f32 v91, v91
  v_cvt_pk_bf16_f32 v64, v88, v89
  v_cvt_pk_bf16_f32 v65, v90, v91
  v_mfma_f32_32x32x16_bf16 v[72:87], v[34:37], v[16:19], v[72:87]
  ds_read_b128 v[52:55], v5 offset:6400
  v_exp_f32 v92, v92
  v_exp_f32 v93, v93
  v_exp_f32 v94, v94
  v_exp_f32 v95, v95
  v_cvt_pk_bf16_f32 v66, v92, v93
  v_cvt_pk_bf16_f32 v67, v94, v95
  v_mfma_f32_32x32x16_bf16 v[104:119], v[44:47], v[60:63], v[104:119]
  v_exp_f32 v96, v96
  v_exp_f32 v97, v97
  v_exp_f32 v98, v98
  v_exp_f32 v99, v99
  v_cvt_pk_bf16_f32 v68, v96, v97
  v_cvt_pk_bf16_f32 v69, v98, v99
  v_mfma_f32_32x32x16_bf16 v[120:135], v[40:43], v[64:67], v[120:135]
  v_exp_f32 v100, v100
  v_exp_f32 v101, v101
  v_exp_f32 v102, v102
  v_exp_f32 v103, v103
  v_cvt_pk_bf16_f32 v70, v100, v101
  v_cvt_pk_bf16_f32 v71, v102, v103
  s_waitcnt lgkmcnt(0)
  v_mfma_f32_32x32x8bf16_1k v[88:103], v[38:39], v[26:27], 0
  ds_read_b64 v[32:33], v4 offset:11264
  v_exp_f32 v72, v72
  v_exp_f32 v73, v73
  v_exp_f32 v74, v74
  v_exp_f32 v75, v75
  v_cvt_pk_bf16_f32 v56, v72, v73
  v_cvt_pk_bf16_f32 v57, v74, v75
  v_mfma_f32_32x32x16_bf16 v[88:103], v[34:37], v[20:23], v[88:103]
  ds_read_b128 v[28:31], v3 offset:11264
  v_exp_f32 v76, v76
  v_exp_f32 v77, v77
  v_exp_f32 v78, v78
  v_exp_f32 v79, v79
  v_cvt_pk_bf16_f32 v58, v76, v77
  v_cvt_pk_bf16_f32 v59, v78, v79
  v_mfma_f32_32x32x16_bf16 v[120:135], v[44:47], v[68:71], v[120:135]
  v_exp_f32 v80, v80
  v_exp_f32 v81, v81
  v_exp_f32 v82, v82
  v_exp_f32 v83, v83
  v_cvt_pk_bf16_f32 v60, v80, v81
  v_cvt_pk_bf16_f32 v61, v82, v83
  v_mfma_f32_32x32x16_bf16 v[104:119], v[48:51], v[56:59], v[104:119]
  v_exp_f32 v84, v84
  v_exp_f32 v85, v85
  v_exp_f32 v86, v86
  v_exp_f32 v87, v87
  v_cvt_pk_bf16_f32 v62, v84, v85
  v_cvt_pk_bf16_f32 v63, v86, v87
  s_waitcnt lgkmcnt(0)
  v_mfma_f32_32x32x8bf16_1k v[72:87], v[32:33], v[24:25], 0
  ds_read_b128 v[40:43], v5 offset:11264
  v_exp_f32 v88, v88
  v_exp_f32 v89, v89
  v_exp_f32 v90, v90
  v_exp_f32 v91, v91
  v_cvt_pk_bf16_f32 v64, v88, v89
  v_cvt_pk_bf16_f32 v65, v90, v91
  v_mfma_f32_32x32x16_bf16 v[72:87], v[28:31], v[16:19], v[72:87]
  ds_read_b128 v[44:47], v5 offset:12032
  v_exp_f32 v92, v92
  v_exp_f32 v93, v93
  v_exp_f32 v94, v94
  v_exp_f32 v95, v95
  v_cvt_pk_bf16_f32 v66, v92, v93
  v_cvt_pk_bf16_f32 v67, v94, v95
  v_mfma_f32_32x32x16_bf16 v[104:119], v[52:55], v[60:63], v[104:119]
  v_exp_f32 v96, v96
  v_exp_f32 v97, v97
  v_exp_f32 v98, v98
  v_exp_f32 v99, v99
  v_cvt_pk_bf16_f32 v68, v96, v97
  v_cvt_pk_bf16_f32 v69, v98, v99
  v_mfma_f32_32x32x16_bf16 v[120:135], v[48:51], v[64:67], v[120:135]
  v_exp_f32 v100, v100
  v_exp_f32 v101, v101
  v_exp_f32 v102, v102
  v_exp_f32 v103, v103
  v_cvt_pk_bf16_f32 v70, v100, v101
  v_cvt_pk_bf16_f32 v71, v102, v103
  s_waitcnt lgkmcnt(0)
  v_mfma_f32_32x32x8bf16_1k v[88:103], v[32:33], v[26:27], 0
  ds_read_b64 v[38:39], v4 offset:16896
  v_exp_f32 v72, v72
  v_exp_f32 v73, v73
  v_exp_f32 v74, v74
  v_exp_f32 v75, v75
  v_cvt_pk_bf16_f32 v56, v72, v73
  v_cvt_pk_bf16_f32 v57, v74, v75
  v_mfma_f32_32x32x16_bf16 v[88:103], v[28:31], v[20:23], v[88:103]
  ds_read_b128 v[34:37], v3 offset:16896
  v_exp_f32 v76, v76
  v_exp_f32 v77, v77
  v_exp_f32 v78, v78
  v_exp_f32 v79, v79
  v_cvt_pk_bf16_f32 v58, v76, v77
  v_cvt_pk_bf16_f32 v59, v78, v79
  v_mfma_f32_32x32x16_bf16 v[120:135], v[52:55], v[68:71], v[120:135]
  v_exp_f32 v80, v80
  v_exp_f32 v81, v81
  v_exp_f32 v82, v82
  v_exp_f32 v83, v83
  v_cvt_pk_bf16_f32 v60, v80, v81
  v_cvt_pk_bf16_f32 v61, v82, v83
  v_mfma_f32_32x32x16_bf16 v[104:119], v[40:43], v[56:59], v[104:119]
  v_exp_f32 v84, v84
  v_exp_f32 v85, v85
  v_exp_f32 v86, v86
  v_exp_f32 v87, v87
  v_cvt_pk_bf16_f32 v62, v84, v85
  v_cvt_pk_bf16_f32 v63, v86, v87
  s_waitcnt lgkmcnt(0)
  v_mfma_f32_32x32x8bf16_1k v[72:87], v[38:39], v[24:25], 0
  ds_read_b128 v[48:51], v5 offset:16896
  v_exp_f32 v88, v88
  v_exp_f32 v89, v89
  v_exp_f32 v90, v90
  v_exp_f32 v91, v91
  v_cvt_pk_bf16_f32 v64, v88, v89
  v_cvt_pk_bf16_f32 v65, v90, v91
  v_mfma_f32_32x32x16_bf16 v[72:87], v[34:37], v[16:19], v[72:87]
  ds_read_b128 v[52:55], v5 offset:17664
  v_exp_f32 v92, v92
  v_exp_f32 v93, v93
  v_exp_f32 v94, v94
  v_exp_f32 v95, v95
  v_cvt_pk_bf16_f32 v66, v92, v93
  v_cvt_pk_bf16_f32 v67, v94, v95
  v_mfma_f32_32x32x16_bf16 v[104:119], v[44:47], v[60:63], v[104:119]
  v_exp_f32 v96, v96
  v_exp_f32 v97, v97
  v_exp_f32 v98, v98
  v_exp_f32 v99, v99
  v_cvt_pk_bf16_f32 v68, v96, v97
  v_cvt_pk_bf16_f32 v69, v98, v99
  v_mfma_f32_32x32x16_bf16 v[120:135], v[40:43], v[64:67], v[120:135]
  v_exp_f32 v100, v100
  v_exp_f32 v101, v101
  v_exp_f32 v102, v102
  v_exp_f32 v103, v103
  v_cvt_pk_bf16_f32 v70, v100, v101
  v_cvt_pk_bf16_f32 v71, v102, v103
  s_waitcnt vmcnt(0) lgkmcnt(0)
  s_barrier
  v_mfma_f32_32x32x8bf16_1k v[88:103], v[38:39], v[26:27], 0
  ds_read_b64 v[32:33], v4 offset:45056
  s_add_u32 m0, s28, 0
  s_add_u32 s30, s26, 270336
  buffer_load_dwordx4 v6, s[16:19], s30 offen sc1 lds
  v_exp_f32 v72, v72
  v_exp_f32 v73, v73
  v_exp_f32 v74, v74
  v_exp_f32 v75, v75
  v_cvt_pk_bf16_f32 v56, v72, v73
  v_cvt_pk_bf16_f32 v57, v74, v75
  v_mfma_f32_32x32x16_bf16 v[88:103], v[34:37], v[20:23], v[88:103]
  ds_read_b128 v[28:31], v3 offset:45056
  s_add_u32 m0, s28, 8192
  s_add_u32 s30, s26, 278528
  buffer_load_dwordx4 v6, s[16:19], s30 offen sc1 lds
  v_exp_f32 v76, v76
  v_exp_f32 v77, v77
  v_exp_f32 v78, v78
  v_exp_f32 v79, v79
  v_cvt_pk_bf16_f32 v58, v76, v77
  v_cvt_pk_bf16_f32 v59, v78, v79
  v_mfma_f32_32x32x16_bf16 v[120:135], v[44:47], v[68:71], v[120:135]
  s_add_u32 m0, s28, 16384
  s_add_u32 s30, s26, 286720
  buffer_load_dwordx4 v6, s[16:19], s30 offen sc1 lds
  v_exp_f32 v80, v80
  v_exp_f32 v81, v81
  v_exp_f32 v82, v82
  v_exp_f32 v83, v83
  v_cvt_pk_bf16_f32 v60, v80, v81
  v_cvt_pk_bf16_f32 v61, v82, v83
  v_mfma_f32_32x32x16_bf16 v[104:119], v[48:51], v[56:59], v[104:119]
  s_add_u32 m0, s28, 24576
  s_add_u32 s30, s26, 294912
  buffer_load_dwordx4 v6, s[16:19], s30 offen sc1 lds
  v_exp_f32 v84, v84
  v_exp_f32 v85, v85
  v_exp_f32 v86, v86
  v_exp_f32 v87, v87
  v_cvt_pk_bf16_f32 v62, v84, v85
  v_cvt_pk_bf16_f32 v63, v86, v87
  s_waitcnt lgkmcnt(0)
  v_mfma_f32_32x32x8bf16_1k v[72:87], v[32:33], v[24:25], 0
  ds_read_b128 v[40:43], v5 offset:45056
  s_add_u32 m0, s28, 32768
  s_add_u32 s30, s26, 303104
  buffer_load_dwordx4 v6, s[16:19], s30 offen sc1 lds
  s_cmp_lg_u32 s20, 0
  s_cbranch_scc1 gated_mix__softmax_full_mha__sliding_local_dilated__prompt_kernel_z3
  s_lshl_b32 s8, s22, 4
  s_add_u32 s8, s8, s21
  s_lshl_b32 s8, s8, 2
  s_add_u32 s8, s8, 26279936
  s_mov_b64 exec, 1
  v_mov_b32 v8, s66
  v_mov_b32 v9, 0
  buffer_store_dword v8, v9, s[16:19], s8 offen sc1
  s_mov_b64 exec, -1
gated_mix__softmax_full_mha__sliding_local_dilated__prompt_kernel_z3:
  v_exp_f32 v88, v88
  v_exp_f32 v89, v89
  v_exp_f32 v90, v90
  v_exp_f32 v91, v91
  v_cvt_pk_bf16_f32 v64, v88, v89
  v_cvt_pk_bf16_f32 v65, v90, v91
  v_mfma_f32_32x32x16_bf16 v[72:87], v[28:31], v[16:19], v[72:87]
  ds_read_b128 v[44:47], v5 offset:45824
  s_add_u32 m0, s38, 0
  s_add_u32 s30, s26, 270336
  s_mov_b32 exec_hi, 0
  buffer_load_dwordx4 v7, s[16:19], s30 offen sc1 lds
  s_mov_b64 exec, -1
  v_exp_f32 v92, v92
  v_exp_f32 v93, v93
  v_exp_f32 v94, v94
  v_exp_f32 v95, v95
  v_cvt_pk_bf16_f32 v66, v92, v93
  v_cvt_pk_bf16_f32 v67, v94, v95
  v_mfma_f32_32x32x16_bf16 v[104:119], v[52:55], v[60:63], v[104:119]
  v_exp_f32 v96, v96
  v_exp_f32 v97, v97
  v_exp_f32 v98, v98
  v_exp_f32 v99, v99
  v_cvt_pk_bf16_f32 v68, v96, v97
  v_cvt_pk_bf16_f32 v69, v98, v99
  v_mfma_f32_32x32x16_bf16 v[120:135], v[48:51], v[64:67], v[120:135]
  v_exp_f32 v100, v100
  v_exp_f32 v101, v101
  v_exp_f32 v102, v102
  v_exp_f32 v103, v103
  v_cvt_pk_bf16_f32 v70, v100, v101
  v_cvt_pk_bf16_f32 v71, v102, v103
  s_waitcnt lgkmcnt(0)
  v_mfma_f32_32x32x8bf16_1k v[88:103], v[32:33], v[26:27], 0
  ds_read_b64 v[38:39], v4 offset:50688
  s_add_u32 m0, s65, 102400
  s_mov_b32 s9, 0
  s_mov_b64 exec, s[58:59]
  buffer_load_dwordx4 v221, s[44:47], s9 offen lds
  s_mov_b64 exec, -1
  v_exp_f32 v72, v72
  v_exp_f32 v73, v73
  v_exp_f32 v74, v74
  v_exp_f32 v75, v75
  v_cvt_pk_bf16_f32 v56, v72, v73
  v_cvt_pk_bf16_f32 v57, v74, v75
  v_mfma_f32_32x32x16_bf16 v[88:103], v[28:31], v[20:23], v[88:103]
  ds_read_b128 v[34:37], v3 offset:50688
  s_add_u32 m0, s65, 103360
  s_mov_b32 s9, 6400
  s_mov_b64 exec, s[58:59]
  buffer_load_dwordx4 v221, s[44:47], s9 offen lds
  s_mov_b64 exec, -1
  v_exp_f32 v76, v76
  v_exp_f32 v77, v77
  v_exp_f32 v78, v78
  v_exp_f32 v79, v79
  v_cvt_pk_bf16_f32 v58, v76, v77
  v_cvt_pk_bf16_f32 v59, v78, v79
  v_mfma_f32_32x32x16_bf16 v[120:135], v[52:55], v[68:71], v[120:135]
  s_add_u32 m0, s65, 104320
  s_mov_b32 s9, 12800
  s_mov_b64 exec, s[58:59]
  buffer_load_dwordx4 v221, s[44:47], s9 offen lds
  s_mov_b64 exec, -1
  v_exp_f32 v80, v80
  v_exp_f32 v81, v81
  v_exp_f32 v82, v82
  v_exp_f32 v83, v83
  v_cvt_pk_bf16_f32 v60, v80, v81
  v_cvt_pk_bf16_f32 v61, v82, v83
  v_mfma_f32_32x32x16_bf16 v[104:119], v[40:43], v[56:59], v[104:119]
  s_add_u32 m0, s65, 105280
  s_mov_b32 s9, 19200
  s_mov_b64 exec, s[58:59]
  buffer_load_dwordx4 v221, s[44:47], s9 offen lds
  s_mov_b64 exec, -1
  v_exp_f32 v84, v84
  v_exp_f32 v85, v85
  v_exp_f32 v86, v86
  v_exp_f32 v87, v87
  v_cvt_pk_bf16_f32 v62, v84, v85
  v_cvt_pk_bf16_f32 v63, v86, v87
  s_waitcnt lgkmcnt(0)
  v_mfma_f32_32x32x8bf16_1k v[72:87], v[38:39], v[24:25], 0
  ds_read_b128 v[48:51], v5 offset:50688
  s_add_u32 m0, s65, 106240
  s_mov_b32 s9, 25600
  s_mov_b64 exec, s[58:59]
  buffer_load_dwordx4 v221, s[44:47], s9 offen lds
  s_mov_b64 exec, -1
  v_exp_f32 v88, v88
  v_exp_f32 v89, v89
  v_exp_f32 v90, v90
  v_exp_f32 v91, v91
  v_cvt_pk_bf16_f32 v64, v88, v89
  v_cvt_pk_bf16_f32 v65, v90, v91
  v_mfma_f32_32x32x16_bf16 v[72:87], v[34:37], v[16:19], v[72:87]
  ds_read_b128 v[52:55], v5 offset:51456
  s_add_u32 m0, s65, 107200
  s_mov_b32 s9, 32000
  s_mov_b64 exec, s[58:59]
  buffer_load_dwordx4 v221, s[44:47], s9 offen lds
  s_mov_b64 exec, -1
  v_exp_f32 v92, v92
  v_exp_f32 v93, v93
  v_exp_f32 v94, v94
  v_exp_f32 v95, v95
  v_cvt_pk_bf16_f32 v66, v92, v93
  v_cvt_pk_bf16_f32 v67, v94, v95
  v_mfma_f32_32x32x16_bf16 v[104:119], v[44:47], v[60:63], v[104:119]
  s_add_u32 m0, s65, 108160
  s_mov_b32 s9, 38400
  s_mov_b64 exec, s[58:59]
  buffer_load_dwordx4 v221, s[44:47], s9 offen lds
  s_mov_b64 exec, -1
  v_exp_f32 v96, v96
  v_exp_f32 v97, v97
  v_exp_f32 v98, v98
  v_exp_f32 v99, v99
  v_cvt_pk_bf16_f32 v68, v96, v97
  v_cvt_pk_bf16_f32 v69, v98, v99
  v_mfma_f32_32x32x16_bf16 v[120:135], v[40:43], v[64:67], v[120:135]
  s_add_u32 m0, s65, 109120
  s_mov_b32 s9, 44800
  s_mov_b64 exec, s[58:59]
  buffer_load_dwordx4 v221, s[44:47], s9 offen lds
  s_mov_b64 exec, -1
  v_exp_f32 v100, v100
  v_exp_f32 v101, v101
  v_exp_f32 v102, v102
  v_exp_f32 v103, v103
  v_cvt_pk_bf16_f32 v70, v100, v101
  v_cvt_pk_bf16_f32 v71, v102, v103
  s_waitcnt lgkmcnt(0)
  v_mfma_f32_32x32x8bf16_1k v[88:103], v[38:39], v[26:27], 0
  ds_read_b64 v[32:33], v4 offset:56320
  v_exp_f32 v72, v72
  v_exp_f32 v73, v73
  v_exp_f32 v74, v74
  v_exp_f32 v75, v75
  v_cvt_pk_bf16_f32 v56, v72, v73
  v_cvt_pk_bf16_f32 v57, v74, v75
  v_mfma_f32_32x32x16_bf16 v[88:103], v[34:37], v[20:23], v[88:103]
  ds_read_b128 v[28:31], v3 offset:56320
  v_exp_f32 v76, v76
  v_exp_f32 v77, v77
  v_exp_f32 v78, v78
  v_exp_f32 v79, v79
  v_cvt_pk_bf16_f32 v58, v76, v77
  v_cvt_pk_bf16_f32 v59, v78, v79
  v_mfma_f32_32x32x16_bf16 v[120:135], v[44:47], v[68:71], v[120:135]
  v_exp_f32 v80, v80
  v_exp_f32 v81, v81
  v_exp_f32 v82, v82
  v_exp_f32 v83, v83
  v_cvt_pk_bf16_f32 v60, v80, v81
  v_cvt_pk_bf16_f32 v61, v82, v83
  v_mfma_f32_32x32x16_bf16 v[104:119], v[48:51], v[56:59], v[104:119]
  v_exp_f32 v84, v84
  v_exp_f32 v85, v85
  v_exp_f32 v86, v86
  v_exp_f32 v87, v87
  v_cvt_pk_bf16_f32 v62, v84, v85
  v_cvt_pk_bf16_f32 v63, v86, v87
  s_waitcnt lgkmcnt(0)
  v_mfma_f32_32x32x8bf16_1k v[72:87], v[32:33], v[24:25], 0
  ds_read_b128 v[40:43], v5 offset:56320
  v_exp_f32 v88, v88
  v_exp_f32 v89, v89
  v_exp_f32 v90, v90
  v_exp_f32 v91, v91
  v_cvt_pk_bf16_f32 v64, v88, v89
  v_cvt_pk_bf16_f32 v65, v90, v91
  v_mfma_f32_32x32x16_bf16 v[72:87], v[28:31], v[16:19], v[72:87]
  ds_read_b128 v[44:47], v5 offset:57088
  v_exp_f32 v92, v92
  v_exp_f32 v93, v93
  v_exp_f32 v94, v94
  v_exp_f32 v95, v95
  v_cvt_pk_bf16_f32 v66, v92, v93
  v_cvt_pk_bf16_f32 v67, v94, v95
  v_mfma_f32_32x32x16_bf16 v[104:119], v[52:55], v[60:63], v[104:119]
  v_exp_f32 v96, v96
  v_exp_f32 v97, v97
  v_exp_f32 v98, v98
  v_exp_f32 v99, v99
  v_cvt_pk_bf16_f32 v68, v96, v97
  v_cvt_pk_bf16_f32 v69, v98, v99
  v_mfma_f32_32x32x16_bf16 v[120:135], v[48:51], v[64:67], v[120:135]
  v_exp_f32 v100, v100
  v_exp_f32 v101, v101
  v_exp_f32 v102, v102
  v_exp_f32 v103, v103
  v_cvt_pk_bf16_f32 v70, v100, v101
  v_cvt_pk_bf16_f32 v71, v102, v103
  s_waitcnt lgkmcnt(0)
  v_mfma_f32_32x32x8bf16_1k v[88:103], v[32:33], v[26:27], 0
  ds_read_b64 v[38:39], v4 offset:61952
  v_exp_f32 v72, v72
  v_exp_f32 v73, v73
  v_exp_f32 v74, v74
  v_exp_f32 v75, v75
  v_cvt_pk_bf16_f32 v56, v72, v73
  v_cvt_pk_bf16_f32 v57, v74, v75
  v_mfma_f32_32x32x16_bf16 v[88:103], v[28:31], v[20:23], v[88:103]
  ds_read_b128 v[34:37], v3 offset:61952
  v_exp_f32 v76, v76
  v_exp_f32 v77, v77
  v_exp_f32 v78, v78
  v_exp_f32 v79, v79
  v_cvt_pk_bf16_f32 v58, v76, v77
  v_cvt_pk_bf16_f32 v59, v78, v79
  v_mfma_f32_32x32x16_bf16 v[120:135], v[52:55], v[68:71], v[120:135]
  v_exp_f32 v80, v80
  v_exp_f32 v81, v81
  v_exp_f32 v82, v82
  v_exp_f32 v83, v83
  v_cvt_pk_bf16_f32 v60, v80, v81
  v_cvt_pk_bf16_f32 v61, v82, v83
  v_mfma_f32_32x32x16_bf16 v[104:119], v[40:43], v[56:59], v[104:119]
  v_exp_f32 v84, v84
  v_exp_f32 v85, v85
  v_exp_f32 v86, v86
  v_exp_f32 v87, v87
  v_cvt_pk_bf16_f32 v62, v84, v85
  v_cvt_pk_bf16_f32 v63, v86, v87
  s_waitcnt lgkmcnt(0)
  v_mfma_f32_32x32x8bf16_1k v[72:87], v[38:39], v[24:25], 0
  ds_read_b128 v[48:51], v5 offset:61952
  v_exp_f32 v88, v88
  v_exp_f32 v89, v89
  v_exp_f32 v90, v90
  v_exp_f32 v91, v91
  v_cvt_pk_bf16_f32 v64, v88, v89
  v_cvt_pk_bf16_f32 v65, v90, v91
  v_mfma_f32_32x32x16_bf16 v[72:87], v[34:37], v[16:19], v[72:87]
  ds_read_b128 v[52:55], v5 offset:62720
  v_exp_f32 v92, v92
  v_exp_f32 v93, v93
  v_exp_f32 v94, v94
  v_exp_f32 v95, v95
  v_cvt_pk_bf16_f32 v66, v92, v93
  v_cvt_pk_bf16_f32 v67, v94, v95
  v_mfma_f32_32x32x16_bf16 v[104:119], v[44:47], v[60:63], v[104:119]
  v_exp_f32 v96, v96
  v_exp_f32 v97, v97
  v_exp_f32 v98, v98
  v_exp_f32 v99, v99
  v_cvt_pk_bf16_f32 v68, v96, v97
  v_cvt_pk_bf16_f32 v69, v98, v99
  v_mfma_f32_32x32x16_bf16 v[120:135], v[40:43], v[64:67], v[120:135]
  v_exp_f32 v100, v100
  v_exp_f32 v101, v101
  v_exp_f32 v102, v102
  v_exp_f32 v103, v103
  v_cvt_pk_bf16_f32 v70, v100, v101
  v_cvt_pk_bf16_f32 v71, v102, v103
  s_waitcnt vmcnt(0) lgkmcnt(0)
  s_barrier
  v_mfma_f32_32x32x8bf16_1k v[88:103], v[38:39], v[26:27], 0
  ds_read_b64 v[32:33], v4 offset:0
  s_add_u32 m0, s28, 45056
  s_add_u32 s30, s26, 315392
  buffer_load_dwordx4 v6, s[16:19], s30 offen sc1 lds
  v_exp_f32 v72, v72
  v_exp_f32 v73, v73
  v_exp_f32 v74, v74
  v_exp_f32 v75, v75
  v_cvt_pk_bf16_f32 v56, v72, v73
  v_cvt_pk_bf16_f32 v57, v74, v75
  v_mfma_f32_32x32x16_bf16 v[88:103], v[34:37], v[20:23], v[88:103]
  ds_read_b128 v[28:31], v3 offset:0
  s_add_u32 m0, s28, 53248
  s_add_u32 s30, s26, 323584
  buffer_load_dwordx4 v6, s[16:19], s30 offen sc1 lds
  v_exp_f32 v76, v76
  v_exp_f32 v77, v77
  v_exp_f32 v78, v78
  v_exp_f32 v79, v79
  v_cvt_pk_bf16_f32 v58, v76, v77
  v_cvt_pk_bf16_f32 v59, v78, v79
  v_mfma_f32_32x32x16_bf16 v[120:135], v[44:47], v[68:71], v[120:135]
  s_add_u32 m0, s28, 61440
  s_add_u32 s30, s26, 331776
  buffer_load_dwordx4 v6, s[16:19], s30 offen sc1 lds
  v_exp_f32 v80, v80
  v_exp_f32 v81, v81
  v_exp_f32 v82, v82
  v_exp_f32 v83, v83
  v_cvt_pk_bf16_f32 v60, v80, v81
  v_cvt_pk_bf16_f32 v61, v82, v83
  v_mfma_f32_32x32x16_bf16 v[104:119], v[48:51], v[56:59], v[104:119]
  s_add_u32 m0, s28, 69632
  s_add_u32 s30, s26, 339968
  buffer_load_dwordx4 v6, s[16:19], s30 offen sc1 lds
  v_exp_f32 v84, v84
  v_exp_f32 v85, v85
  v_exp_f32 v86, v86
  v_exp_f32 v87, v87
  v_cvt_pk_bf16_f32 v62, v84, v85
  v_cvt_pk_bf16_f32 v63, v86, v87
  s_waitcnt lgkmcnt(0)
  v_mfma_f32_32x32x8bf16_1k v[72:87], v[32:33], v[24:25], 0
  ds_read_b128 v[40:43], v5 offset:0
  s_add_u32 m0, s28, 77824
  s_add_u32 s30, s26, 348160
  buffer_load_dwordx4 v6, s[16:19], s30 offen sc1 lds
  v_exp_f32 v88, v88
  v_exp_f32 v89, v89
  v_exp_f32 v90, v90
  v_exp_f32 v91, v91
  v_cvt_pk_bf16_f32 v64, v88, v89
  v_cvt_pk_bf16_f32 v65, v90, v91
  v_mfma_f32_32x32x16_bf16 v[72:87], v[28:31], v[16:19], v[72:87]
  ds_read_b128 v[44:47], v5 offset:768
  s_add_u32 m0, s38, 45056
  s_add_u32 s30, s26, 315392
  s_mov_b32 exec_hi, 0
  buffer_load_dwordx4 v7, s[16:19], s30 offen sc1 lds
  s_mov_b64 exec, -1
  v_exp_f32 v92, v92
  v_exp_f32 v93, v93
  v_exp_f32 v94, v94
  v_exp_f32 v95, v95
  v_cvt_pk_bf16_f32 v66, v92, v93
  v_cvt_pk_bf16_f32 v67, v94, v95
  v_mfma_f32_32x32x16_bf16 v[104:119], v[52:55], v[60:63], v[104:119]
  v_exp_f32 v96, v96
  v_exp_f32 v97, v97
  v_exp_f32 v98, v98
  v_exp_f32 v99, v99
  v_cvt_pk_bf16_f32 v68, v96, v97
  v_cvt_pk_bf16_f32 v69, v98, v99
  v_mfma_f32_32x32x16_bf16 v[120:135], v[48:51], v[64:67], v[120:135]
  v_exp_f32 v100, v100
  v_exp_f32 v101, v101
  v_exp_f32 v102, v102
  v_exp_f32 v103, v103
  v_cvt_pk_bf16_f32 v70, v100, v101
  v_cvt_pk_bf16_f32 v71, v102, v103
  s_waitcnt lgkmcnt(0)
  v_mfma_f32_32x32x8bf16_1k v[88:103], v[32:33], v[26:27], 0
  ds_read_b64 v[38:39], v4 offset:5632
  s_cmp_lg_u32 s20, 0
  s_cbranch_scc1 gated_mix__softmax_full_mha__sliding_local_dilated__prompt_kernel_z5
  v_and_b32 v236, 15, v2
  v_lshlrev_b32 v236, 2, v236
  s_lshl_b32 s91, s64, 6
  s_add_u32 s91, s91, 26279936
  buffer_load_dword v232, v236, s[16:19], s91 offen sc1
gated_mix__softmax_full_mha__sliding_local_dilated__prompt_kernel_z5:
  v_exp_f32 v72, v72
  v_exp_f32 v73, v73
  v_exp_f32 v74, v74
  v_exp_f32 v75, v75
  v_cvt_pk_bf16_f32 v56, v72, v73
  v_cvt_pk_bf16_f32 v57, v74, v75
  v_mfma_f32_32x32x16_bf16 v[88:103], v[28:31], v[20:23], v[88:103]
  ds_read_b128 v[34:37], v3 offset:5632
  v_exp_f32 v76, v76
  v_exp_f32 v77, v77
  v_exp_f32 v78, v78
  v_exp_f32 v79, v79
  v_cvt_pk_bf16_f32 v58, v76, v77
  v_cvt_pk_bf16_f32 v59, v78, v79
  v_mfma_f32_32x32x16_bf16 v[120:135], v[52:55], v[68:71], v[120:135]
  v_exp_f32 v80, v80
  v_exp_f32 v81, v81
  v_exp_f32 v82, v82
  v_exp_f32 v83, v83
  v_cvt_pk_bf16_f32 v60, v80, v81
  v_cvt_pk_bf16_f32 v61, v82, v83
  v_mfma_f32_32x32x16_bf16 v[104:119], v[40:43], v[56:59], v[104:119]
  v_exp_f32 v84, v84
  v_exp_f32 v85, v85
  v_exp_f32 v86, v86
  v_exp_f32 v87, v87
  v_cvt_pk_bf16_f32 v62, v84, v85
  v_cvt_pk_bf16_f32 v63, v86, v87
  s_waitcnt lgkmcnt(0)
  v_mfma_f32_32x32x8bf16_1k v[72:87], v[38:39], v[24:25], 0
  ds_read_b128 v[48:51], v5 offset:5632
  v_exp_f32 v88, v88
  v_exp_f32 v89, v89
  v_exp_f32 v90, v90
  v_exp_f32 v91, v91
  v_cvt_pk_bf16_f32 v64, v88, v89
  v_cvt_pk_bf16_f32 v65, v90, v91
  v_mfma_f32_32x32x16_bf16 v[72:87], v[34:37], v[16:19], v[72:87]
  ds_read_b128 v[52:55], v5 offset:6400
  v_exp_f32 v92, v92
  v_exp_f32 v93, v93
  v_exp_f32 v94, v94
  v_exp_f32 v95, v95
  v_cvt_pk_bf16_f32 v66, v92, v93
  v_cvt_pk_bf16_f32 v67, v94, v95
  v_mfma_f32_32x32x16_bf16 v[104:119], v[44:47], v[60:63], v[104:119]
  v_exp_f32 v96, v96
  v_exp_f32 v97, v97
  v_exp_f32 v98, v98
  v_exp_f32 v99, v99
  v_cvt_pk_bf16_f32 v68, v96, v97
  v_cvt_pk_bf16_f32 v69, v98, v99
  v_mfma_f32_32x32x16_bf16 v[120:135], v[40:43], v[64:67], v[120:135]
  v_exp_f32 v100, v100
  v_exp_f32 v101, v101
  v_exp_f32 v102, v102
  v_exp_f32 v103, v103
  v_cvt_pk_bf16_f32 v70, v100, v101
  v_cvt_pk_bf16_f32 v71, v102, v103
  s_waitcnt lgkmcnt(0)
  v_mfma_f32_32x32x8bf16_1k v[88:103], v[38:39], v[26:27], 0
  ds_read_b64 v[32:33], v4 offset:11264
  v_exp_f32 v72, v72
  v_exp_f32 v73, v73
  v_exp_f32 v74, v74
  v_exp_f32 v75, v75
  v_cvt_pk_bf16_f32 v56, v72, v73
  v_cvt_pk_bf16_f32 v57, v74, v75
  v_mfma_f32_32x32x16_bf16 v[88:103], v[34:37], v[20:23], v[88:103]
  ds_read_b128 v[28:31], v3 offset:11264
  v_exp_f32 v76, v76
  v_exp_f32 v77, v77
  v_exp_f32 v78, v78
  v_exp_f32 v79, v79
  v_cvt_pk_bf16_f32 v58, v76, v77
  v_cvt_pk_bf16_f32 v59, v78, v79
  v_mfma_f32_32x32x16_bf16 v[120:135], v[44:47], v[68:71], v[120:135]
  v_exp_f32 v80, v80
  v_exp_f32 v81, v81
  v_exp_f32 v82, v82
  v_exp_f32 v83, v83
  v_cvt_pk_bf16_f32 v60, v80, v81
  v_cvt_pk_bf16_f32 v61, v82, v83
  v_mfma_f32_32x32x16_bf16 v[104:119], v[48:51], v[56:59], v[104:119]
  v_exp_f32 v84, v84
  v_exp_f32 v85, v85
  v_exp_f32 v86, v86
  v_exp_f32 v87, v87
  v_cvt_pk_bf16_f32 v62, v84, v85
  v_cvt_pk_bf16_f32 v63, v86, v87
  s_waitcnt lgkmcnt(0)
  v_mfma_f32_32x32x8bf16_1k v[72:87], v[32:33], v[24:25], 0
  ds_read_b128 v[40:43], v5 offset:11264
  v_exp_f32 v88, v88
  v_exp_f32 v89, v89
  v_exp_f32 v90, v90
  v_exp_f32 v91, v91
  v_cvt_pk_bf16_f32 v64, v88, v89
  v_cvt_pk_bf16_f32 v65, v90, v91
  v_mfma_f32_32x32x16_bf16 v[72:87], v[28:31], v[16:19], v[72:87]
  ds_read_b128 v[44:47], v5 offset:12032
  v_exp_f32 v92, v92
  v_exp_f32 v93, v93
  v_exp_f32 v94, v94
  v_exp_f32 v95, v95
  v_cvt_pk_bf16_f32 v66, v92, v93
  v_cvt_pk_bf16_f32 v67, v94, v95
  v_mfma_f32_32x32x16_bf16 v[104:119], v[52:55], v[60:63], v[104:119]
  v_exp_f32 v96, v96
  v_exp_f32 v97, v97
  v_exp_f32 v98, v98
  v_exp_f32 v99, v99
  v_cvt_pk_bf16_f32 v68, v96, v97
  v_cvt_pk_bf16_f32 v69, v98, v99
  v_mfma_f32_32x32x16_bf16 v[120:135], v[48:51], v[64:67], v[120:135]
  v_exp_f32 v100, v100
  v_exp_f32 v101, v101
  v_exp_f32 v102, v102
  v_exp_f32 v103, v103
  v_cvt_pk_bf16_f32 v70, v100, v101
  v_cvt_pk_bf16_f32 v71, v102, v103
  s_waitcnt lgkmcnt(0)
  v_mfma_f32_32x32x8bf16_1k v[88:103], v[32:33], v[26:27], 0
  ds_read_b64 v[38:39], v4 offset:16896
  v_exp_f32 v72, v72
  v_exp_f32 v73, v73
  v_exp_f32 v74, v74
  v_exp_f32 v75, v75
  v_cvt_pk_bf16_f32 v56, v72, v73
  v_cvt_pk_bf16_f32 v57, v74, v75
  v_mfma_f32_32x32x16_bf16 v[88:103], v[28:31], v[20:23], v[88:103]
  ds_read_b128 v[34:37], v3 offset:16896
  v_exp_f32 v76, v76
  v_exp_f32 v77, v77
  v_exp_f32 v78, v78
  v_exp_f32 v79, v79
  v_cvt_pk_bf16_f32 v58, v76, v77
  v_cvt_pk_bf16_f32 v59, v78, v79
  v_mfma_f32_32x32x16_bf16 v[120:135], v[52:55], v[68:71], v[120:135]
  v_exp_f32 v80, v80
  v_exp_f32 v81, v81
  v_exp_f32 v82, v82
  v_exp_f32 v83, v83
  v_cvt_pk_bf16_f32 v60, v80, v81
  v_cvt_pk_bf16_f32 v61, v82, v83
  v_mfma_f32_32x32x16_bf16 v[104:119], v[40:43], v[56:59], v[104:119]
  v_exp_f32 v84, v84
  v_exp_f32 v85, v85
  v_exp_f32 v86, v86
  v_exp_f32 v87, v87
  v_cvt_pk_bf16_f32 v62, v84, v85
  v_cvt_pk_bf16_f32 v63, v86, v87
  s_waitcnt lgkmcnt(0)
  v_mfma_f32_32x32x8bf16_1k v[72:87], v[38:39], v[24:25], 0
  ds_read_b128 v[48:51], v5 offset:16896
  v_exp_f32 v88, v88
  v_exp_f32 v89, v89
  v_exp_f32 v90, v90
  v_exp_f32 v91, v91
  v_cvt_pk_bf16_f32 v64, v88, v89
  v_cvt_pk_bf16_f32 v65, v90, v91
  v_mfma_f32_32x32x16_bf16 v[72:87], v[34:37], v[16:19], v[72:87]
  ds_read_b128 v[52:55], v5 offset:17664
  v_exp_f32 v92, v92
  v_exp_f32 v93, v93
  v_exp_f32 v94, v94
  v_exp_f32 v95, v95
  v_cvt_pk_bf16_f32 v66, v92, v93
  v_cvt_pk_bf16_f32 v67, v94, v95
  v_mfma_f32_32x32x16_bf16 v[104:119], v[44:47], v[60:63], v[104:119]
  v_exp_f32 v96, v96
  v_exp_f32 v97, v97
  v_exp_f32 v98, v98
  v_exp_f32 v99, v99
  v_cvt_pk_bf16_f32 v68, v96, v97
  v_cvt_pk_bf16_f32 v69, v98, v99
  v_mfma_f32_32x32x16_bf16 v[120:135], v[40:43], v[64:67], v[120:135]
  v_exp_f32 v100, v100
  v_exp_f32 v101, v101
  v_exp_f32 v102, v102
  v_exp_f32 v103, v103
  v_cvt_pk_bf16_f32 v70, v100, v101
  v_cvt_pk_bf16_f32 v71, v102, v103
  s_waitcnt vmcnt(0) lgkmcnt(0)
  s_cmp_lg_u32 s20, 0
  s_cbranch_scc1 gated_mix__softmax_full_mha__sliding_local_dilated__prompt_kernel_pb6
  v_cmp_ne_u32 vcc, s66, v232
  s_nop 4
  s_cbranch_vccz gated_mix__softmax_full_mha__sliding_local_dilated__prompt_kernel_pob_early
  v_and_b32 v234, 15, v2
  v_lshlrev_b32 v234, 2, v234
  s_lshl_b32 s91, s64, 6
  s_add_u32 s91, s91, 26279936
  s_mov_b32 s90, 200000
gated_mix__softmax_full_mha__sliding_local_dilated__prompt_kernel_pob:
  buffer_load_dword v232, v234, s[16:19], s91 offen sc1
  s_waitcnt vmcnt(0)
  v_cmp_ne_u32 vcc, s66, v232
  s_nop 4
  s_cbranch_vccz gated_mix__softmax_full_mha__sliding_local_dilated__prompt_kernel_pob_ok
  s_sub_u32 s90, s90, 1
  s_cmp_eq_u32 s90, 0
  s_cbranch_scc1 gated_mix__softmax_full_mha__sliding_local_dilated__prompt_kernel_pob_ok
  s_sleep 1
  s_branch gated_mix__softmax_full_mha__sliding_local_dilated__prompt_kernel_pob
gated_mix__softmax_full_mha__sliding_local_dilated__prompt_kernel_pob_ok:
gated_mix__softmax_full_mha__sliding_local_dilated__prompt_kernel_pob_early:
gated_mix__softmax_full_mha__sliding_local_dilated__prompt_kernel_pb6:
  s_barrier
  v_mfma_f32_32x32x8bf16_1k v[88:103], v[38:39], v[26:27], 0
  ds_read_b64 v[32:33], v4 offset:45056
  s_mov_b32 s9, 0
  buffer_load_dwordx4 v[136:139], v225, s[16:19], s9 offen sc1
  v_exp_f32 v72, v72
  v_exp_f32 v73, v73
  v_exp_f32 v74, v74
  v_exp_f32 v75, v75
  v_cvt_pk_bf16_f32 v56, v72, v73
  v_cvt_pk_bf16_f32 v57, v74, v75
  v_mfma_f32_32x32x16_bf16 v[88:103], v[34:37], v[20:23], v[88:103]
  ds_read_b128 v[28:31], v3 offset:45056
  s_mov_b32 s9, 1024
  buffer_load_dwordx4 v[140:143], v225, s[16:19], s9 offen sc1
  v_exp_f32 v76, v76
  v_exp_f32 v77, v77
  v_exp_f32 v78, v78
  v_exp_f32 v79, v79
  v_cvt_pk_bf16_f32 v58, v76, v77
  v_cvt_pk_bf16_f32 v59, v78, v79
  v_mfma_f32_32x32x16_bf16 v[120:135], v[44:47], v[68:71], v[120:135]
  s_mov_b32 s9, 163840
  buffer_load_dwordx4 v[144:147], v225, s[16:19], s9 offen sc1
  v_exp_f32 v80, v80
  v_exp_f32 v81, v81
  v_exp_f32 v82, v82
  v_exp_f32 v83, v83
  v_cvt_pk_bf16_f32 v60, v80, v81
  v_cvt_pk_bf16_f32 v61, v82, v83
  v_mfma_f32_32x32x16_bf16 v[104:119], v[48:51], v[56:59], v[104:119]
  s_mov_b32 s9, 164864
  buffer_load_dwordx4 v[148:151], v225, s[16:19], s9 offen sc1
  v_exp_f32 v84, v84
  v_exp_f32 v85, v85
  v_exp_f32 v86, v86
  v_exp_f32 v87, v87
  v_cvt_pk_bf16_f32 v62, v84, v85
  v_cvt_pk_bf16_f32 v63, v86, v87
  s_waitcnt lgkmcnt(0)
  v_mfma_f32_32x32x8bf16_1k v[72:87], v[32:33], v[24:25], 0
  ds_read_b128 v[40:43], v5 offset:45056
  s_mov_b32 s9, 0
  buffer_load_dwordx2 v[152:153], v226, s[16:19], s9 offen sc1
  v_exp_f32 v88, v88
  v_exp_f32 v89, v89
  v_exp_f32 v90, v90
  v_exp_f32 v91, v91
  v_cvt_pk_bf16_f32 v64, v88, v89
  v_cvt_pk_bf16_f32 v65, v90, v91
  v_mfma_f32_32x32x16_bf16 v[72:87], v[28:31], v[16:19], v[72:87]
  ds_read_b128 v[44:47], v5 offset:45824
  buffer_load_dwordx2 v[154:155], v226, s[16:19], s9 offen offset:256 sc1
  v_exp_f32 v92, v92
  v_exp_f32 v93, v93
  v_exp_f32 v94, v94
  v_exp_f32 v95, v95
  v_cvt_pk_bf16_f32 v66, v92, v93
  v_cvt_pk_bf16_f32 v67, v94, v95
  v_mfma_f32_32x32x16_bf16 v[104:119], v[52:55], v[60:63], v[104:119]
  s_mov_b32 s9, 1310720
  buffer_load_dwordx4 v[156:159], v225, s[16:19], s9 offen sc1
  v_exp_f32 v96, v96
  v_exp_f32 v97, v97
  v_exp_f32 v98, v98
  v_exp_f32 v99, v99
  v_cvt_pk_bf16_f32 v68, v96, v97
  v_cvt_pk_bf16_f32 v69, v98, v99
  v_mfma_f32_32x32x16_bf16 v[120:135], v[48:51], v[64:67], v[120:135]
  s_mov_b32 s9, 1311744
  buffer_load_dwordx4 v[160:163], v225, s[16:19], s9 offen sc1
  v_exp_f32 v100, v100
  v_exp_f32 v101, v101
  v_exp_f32 v102, v102
  v_exp_f32 v103, v103
  v_cvt_pk_bf16_f32 v70, v100, v101
  v_cvt_pk_bf16_f32 v71, v102, v103
  s_waitcnt lgkmcnt(0)
  v_mfma_f32_32x32x8bf16_1k v[88:103], v[32:33], v[26:27], 0
  ds_read_b64 v[38:39], v4 offset:50688
  s_mov_b32 s9, 1474560
  buffer_load_dwordx4 v[164:167], v225, s[16:19], s9 offen sc1
  v_exp_f32 v72, v72
  v_exp_f32 v73, v73
  v_exp_f32 v74, v74
  v_exp_f32 v75, v75
  v_cvt_pk_bf16_f32 v56, v72, v73
  v_cvt_pk_bf16_f32 v57, v74, v75
  v_mfma_f32_32x32x16_bf16 v[88:103], v[28:31], v[20:23], v[88:103]
  ds_read_b128 v[34:37], v3 offset:50688
  s_mov_b32 s9, 1475584
  buffer_load_dwordx4 v[168:171], v225, s[16:19], s9 offen sc1
  v_exp_f32 v76, v76
  v_exp_f32 v77, v77
  v_exp_f32 v78, v78
  v_exp_f32 v79, v79
  v_cvt_pk_bf16_f32 v58, v76, v77
  v_cvt_pk_bf16_f32 v59, v78, v79
  v_mfma_f32_32x32x16_bf16 v[120:135], v[52:55], v[68:71], v[120:135]
  s_mov_b32 s9, 1310720
  buffer_load_dwordx2 v[172:173], v226, s[16:19], s9 offen sc1
  v_exp_f32 v80, v80
  v_exp_f32 v81, v81
  v_exp_f32 v82, v82
  v_exp_f32 v83, v83
  v_cvt_pk_bf16_f32 v60, v80, v81
  v_cvt_pk_bf16_f32 v61, v82, v83
  v_mfma_f32_32x32x16_bf16 v[104:119], v[40:43], v[56:59], v[104:119]
  buffer_load_dwordx2 v[174:175], v226, s[16:19], s9 offen offset:256 sc1
  v_exp_f32 v84, v84
  v_exp_f32 v85, v85
  v_exp_f32 v86, v86
  v_exp_f32 v87, v87
  v_cvt_pk_bf16_f32 v62, v84, v85
  v_cvt_pk_bf16_f32 v63, v86, v87
  s_waitcnt lgkmcnt(0)
  v_mfma_f32_32x32x8bf16_1k v[72:87], v[38:39], v[24:25], 0
  ds_read_b128 v[48:51], v5 offset:50688
  v_exp_f32 v88, v88
  v_exp_f32 v89, v89
  v_exp_f32 v90, v90
  v_exp_f32 v91, v91
  v_cvt_pk_bf16_f32 v64, v88, v89
  v_cvt_pk_bf16_f32 v65, v90, v91
  v_mfma_f32_32x32x16_bf16 v[72:87], v[34:37], v[16:19], v[72:87]
  ds_read_b128 v[52:55], v5 offset:51456
  v_exp_f32 v92, v92
  v_exp_f32 v93, v93
  v_exp_f32 v94, v94
  v_exp_f32 v95, v95
  v_cvt_pk_bf16_f32 v66, v92, v93
  v_cvt_pk_bf16_f32 v67, v94, v95
  v_mfma_f32_32x32x16_bf16 v[104:119], v[44:47], v[60:63], v[104:119]
  v_exp_f32 v96, v96
  v_exp_f32 v97, v97
  v_exp_f32 v98, v98
  v_exp_f32 v99, v99
  v_cvt_pk_bf16_f32 v68, v96, v97
  v_cvt_pk_bf16_f32 v69, v98, v99
  v_mfma_f32_32x32x16_bf16 v[120:135], v[40:43], v[64:67], v[120:135]
  v_exp_f32 v100, v100
  v_exp_f32 v101, v101
  v_exp_f32 v102, v102
  v_exp_f32 v103, v103
  v_cvt_pk_bf16_f32 v70, v100, v101
  v_cvt_pk_bf16_f32 v71, v102, v103
  s_waitcnt lgkmcnt(0)
  v_mfma_f32_32x32x8bf16_1k v[88:103], v[38:39], v[26:27], 0
  ds_read_b64 v[32:33], v4 offset:56320
  v_exp_f32 v72, v72
  v_exp_f32 v73, v73
  v_exp_f32 v74, v74
  v_exp_f32 v75, v75
  v_cvt_pk_bf16_f32 v56, v72, v73
  v_cvt_pk_bf16_f32 v57, v74, v75
  v_mfma_f32_32x32x16_bf16 v[88:103], v[34:37], v[20:23], v[88:103]
  ds_read_b128 v[28:31], v3 offset:56320
  v_exp_f32 v76, v76
  v_exp_f32 v77, v77
  v_exp_f32 v78, v78
  v_exp_f32 v79, v79
  v_cvt_pk_bf16_f32 v58, v76, v77
  v_cvt_pk_bf16_f32 v59, v78, v79
  v_mfma_f32_32x32x16_bf16 v[120:135], v[44:47], v[68:71], v[120:135]
  v_exp_f32 v80, v80
  v_exp_f32 v81, v81
  v_exp_f32 v82, v82
  v_exp_f32 v83, v83
  v_cvt_pk_bf16_f32 v60, v80, v81
  v_cvt_pk_bf16_f32 v61, v82, v83
  v_mfma_f32_32x32x16_bf16 v[104:119], v[48:51], v[56:59], v[104:119]
  v_exp_f32 v84, v84
  v_exp_f32 v85, v85
  v_exp_f32 v86, v86
  v_exp_f32 v87, v87
  v_cvt_pk_bf16_f32 v62, v84, v85
  v_cvt_pk_bf16_f32 v63, v86, v87
  s_waitcnt lgkmcnt(0)
  v_mfma_f32_32x32x8bf16_1k v[72:87], v[32:33], v[24:25], 0
  ds_read_b128 v[40:43], v5 offset:56320
  v_exp_f32 v88, v88
  v_exp_f32 v89, v89
  v_exp_f32 v90, v90
  v_exp_f32 v91, v91
  v_cvt_pk_bf16_f32 v64, v88, v89
  v_cvt_pk_bf16_f32 v65, v90, v91
  v_mfma_f32_32x32x16_bf16 v[72:87], v[28:31], v[16:19], v[72:87]
  ds_read_b128 v[44:47], v5 offset:57088
  v_exp_f32 v92, v92
  v_exp_f32 v93, v93
  v_exp_f32 v94, v94
  v_exp_f32 v95, v95
  v_cvt_pk_bf16_f32 v66, v92, v93
  v_cvt_pk_bf16_f32 v67, v94, v95
  v_mfma_f32_32x32x16_bf16 v[104:119], v[52:55], v[60:63], v[104:119]
  v_exp_f32 v96, v96
  v_exp_f32 v97, v97
  v_exp_f32 v98, v98
  v_exp_f32 v99, v99
  v_cvt_pk_bf16_f32 v68, v96, v97
  v_cvt_pk_bf16_f32 v69, v98, v99
  v_mfma_f32_32x32x16_bf16 v[120:135], v[48:51], v[64:67], v[120:135]
  v_exp_f32 v100, v100
  v_exp_f32 v101, v101
  v_exp_f32 v102, v102
  v_exp_f32 v103, v103
  v_cvt_pk_bf16_f32 v70, v100, v101
  v_cvt_pk_bf16_f32 v71, v102, v103
  s_waitcnt lgkmcnt(0)
  v_mfma_f32_32x32x8bf16_1k v[88:103], v[32:33], v[26:27], 0
  ds_read_b64 v[38:39], v4 offset:61952
  v_exp_f32 v72, v72
  v_exp_f32 v73, v73
  v_exp_f32 v74, v74
  v_exp_f32 v75, v75
  v_cvt_pk_bf16_f32 v56, v72, v73
  v_cvt_pk_bf16_f32 v57, v74, v75
  v_mfma_f32_32x32x16_bf16 v[88:103], v[28:31], v[20:23], v[88:103]
  ds_read_b128 v[34:37], v3 offset:61952
  v_exp_f32 v76, v76
  v_exp_f32 v77, v77
  v_exp_f32 v78, v78
  v_exp_f32 v79, v79
  v_cvt_pk_bf16_f32 v58, v76, v77
  v_cvt_pk_bf16_f32 v59, v78, v79
  v_mfma_f32_32x32x16_bf16 v[120:135], v[52:55], v[68:71], v[120:135]
  v_exp_f32 v80, v80
  v_exp_f32 v81, v81
  v_exp_f32 v82, v82
  v_exp_f32 v83, v83
  v_cvt_pk_bf16_f32 v60, v80, v81
  v_cvt_pk_bf16_f32 v61, v82, v83
  v_mfma_f32_32x32x16_bf16 v[104:119], v[40:43], v[56:59], v[104:119]
  v_exp_f32 v84, v84
  v_exp_f32 v85, v85
  v_exp_f32 v86, v86
  v_exp_f32 v87, v87
  v_cvt_pk_bf16_f32 v62, v84, v85
  v_cvt_pk_bf16_f32 v63, v86, v87
  s_waitcnt lgkmcnt(0)
  v_mfma_f32_32x32x8bf16_1k v[72:87], v[38:39], v[24:25], 0
  ds_read_b128 v[48:51], v5 offset:61952
  v_exp_f32 v88, v88
  v_exp_f32 v89, v89
  v_exp_f32 v90, v90
  v_exp_f32 v91, v91
  v_cvt_pk_bf16_f32 v64, v88, v89
  v_cvt_pk_bf16_f32 v65, v90, v91
  v_mfma_f32_32x32x16_bf16 v[72:87], v[34:37], v[16:19], v[72:87]
  ds_read_b128 v[52:55], v5 offset:62720
  v_exp_f32 v92, v92
  v_exp_f32 v93, v93
  v_exp_f32 v94, v94
  v_exp_f32 v95, v95
  v_cvt_pk_bf16_f32 v66, v92, v93
  v_cvt_pk_bf16_f32 v67, v94, v95
  v_mfma_f32_32x32x16_bf16 v[104:119], v[44:47], v[60:63], v[104:119]
  v_exp_f32 v96, v96
  v_exp_f32 v97, v97
  v_exp_f32 v98, v98
  v_exp_f32 v99, v99
  v_cvt_pk_bf16_f32 v68, v96, v97
  v_cvt_pk_bf16_f32 v69, v98, v99
  v_mfma_f32_32x32x16_bf16 v[120:135], v[40:43], v[64:67], v[120:135]
  v_exp_f32 v100, v100
  v_exp_f32 v101, v101
  v_exp_f32 v102, v102
  v_exp_f32 v103, v103
  v_cvt_pk_bf16_f32 v70, v100, v101
  v_cvt_pk_bf16_f32 v71, v102, v103
  s_waitcnt vmcnt(0) lgkmcnt(0)
  s_barrier
  v_mfma_f32_32x32x8bf16_1k v[88:103], v[38:39], v[26:27], 0
  v_exp_f32 v72, v72
  v_exp_f32 v73, v73
  v_exp_f32 v74, v74
  v_exp_f32 v75, v75
  v_cvt_pk_bf16_f32 v56, v72, v73
  v_cvt_pk_bf16_f32 v57, v74, v75
  v_mfma_f32_32x32x16_bf16 v[88:103], v[34:37], v[20:23], v[88:103]
  v_exp_f32 v76, v76
  v_exp_f32 v77, v77
  v_exp_f32 v78, v78
  v_exp_f32 v79, v79
  v_cvt_pk_bf16_f32 v58, v76, v77
  v_cvt_pk_bf16_f32 v59, v78, v79
  v_mfma_f32_32x32x16_bf16 v[120:135], v[44:47], v[68:71], v[120:135]
  v_exp_f32 v80, v80
  v_exp_f32 v81, v81
  v_exp_f32 v82, v82
  v_exp_f32 v83, v83
  v_cvt_pk_bf16_f32 v60, v80, v81
  v_cvt_pk_bf16_f32 v61, v82, v83
  v_mfma_f32_32x32x16_bf16 v[104:119], v[48:51], v[56:59], v[104:119]
  v_exp_f32 v84, v84
  v_exp_f32 v85, v85
  v_exp_f32 v86, v86
  v_exp_f32 v87, v87
  v_cvt_pk_bf16_f32 v62, v84, v85
  v_cvt_pk_bf16_f32 v63, v86, v87
  s_waitcnt lgkmcnt(0)
  v_exp_f32 v88, v88
  v_exp_f32 v89, v89
  v_exp_f32 v90, v90
  v_exp_f32 v91, v91
  v_cvt_pk_bf16_f32 v64, v88, v89
  v_cvt_pk_bf16_f32 v65, v90, v91
  v_exp_f32 v92, v92
  v_exp_f32 v93, v93
  v_exp_f32 v94, v94
  v_exp_f32 v95, v95
  v_cvt_pk_bf16_f32 v66, v92, v93
  v_cvt_pk_bf16_f32 v67, v94, v95
  v_mfma_f32_32x32x16_bf16 v[104:119], v[52:55], v[60:63], v[104:119]
  v_exp_f32 v96, v96
  v_exp_f32 v97, v97
  v_exp_f32 v98, v98
  v_exp_f32 v99, v99
  v_cvt_pk_bf16_f32 v68, v96, v97
  v_cvt_pk_bf16_f32 v69, v98, v99
  v_mfma_f32_32x32x16_bf16 v[120:135], v[48:51], v[64:67], v[120:135]
  v_exp_f32 v100, v100
  v_exp_f32 v101, v101
  v_exp_f32 v102, v102
  v_exp_f32 v103, v103
  v_cvt_pk_bf16_f32 v70, v100, v101
  v_cvt_pk_bf16_f32 v71, v102, v103
  s_nop 1
  v_mfma_f32_32x32x16_bf16 v[120:135], v[52:55], v[68:71], v[120:135]
  s_setprio 0
  s_nop 7
  s_nop 3
  s_cmp_eq_u32 s25, 0
  s_cbranch_scc0 gated_mix__softmax_full_mha__sliding_local_dilated__prompt_kernel_h1
  ds_write_b128 v15, v[120:123] offset:0
  ds_write_b128 v15, v[124:127] offset:1024
  ds_write_b128 v15, v[128:131] offset:2048
  s_xor_b32 s8, s20, 4
  s_sub_i32 s8, s8, s20
  s_mul_i32 s8, s8, 3328
  v_add_u32 v10, s8, v15
  s_waitcnt lgkmcnt(0)
  s_barrier
  ds_read_b128 v[232:235], v10 offset:0
  ds_read_b128 v[236:239], v10 offset:1024
  ds_read_b128 v[240:243], v10 offset:2048
  s_waitcnt lgkmcnt(0)
  v_add_f32 v232, v232, v104
  v_add_f32 v233, v233, v105
  v_add_f32 v234, v234, v106
  v_add_f32 v235, v235, v107
  v_add_f32 v236, v236, v108
  v_add_f32 v237, v237, v109
  v_add_f32 v238, v238, v110
  v_add_f32 v239, v239, v111
  v_add_f32 v240, v240, v112
  v_add_f32 v241, v241, v113
  v_add_f32 v242, v242, v114
  v_add_f32 v243, v243, v115
  s_branch gated_mix__softmax_full_mha__sliding_local_dilated__prompt_kernel_comb
gated_mix__softmax_full_mha__sliding_local_dilated__prompt_kernel_h1:
  ds_write_b128 v15, v[104:107] offset:0
  ds_write_b128 v15, v[108:111] offset:1024
  ds_write_b128 v15, v[112:115] offset:2048
  s_xor_b32 s8, s20, 4
  s_sub_i32 s8, s8, s20
  s_mul_i32 s8, s8, 3328
  v_add_u32 v10, s8, v15
  s_waitcnt lgkmcnt(0)
  s_barrier
  ds_read_b128 v[232:235], v10 offset:0
  ds_read_b128 v[236:239], v10 offset:1024
  ds_read_b128 v[240:243], v10 offset:2048
  s_waitcnt lgkmcnt(0)
  v_add_f32 v232, v232, v120
  v_add_f32 v233, v233, v121
  v_add_f32 v234, v234, v122
  v_add_f32 v235, v235, v123
  v_add_f32 v236, v236, v124
  v_add_f32 v237, v237, v125
  v_add_f32 v238, v238, v126
  v_add_f32 v239, v239, v127
  v_add_f32 v240, v240, v128
  v_add_f32 v241, v241, v129
  v_add_f32 v242, v242, v130
  v_add_f32 v243, v243, v131
gated_mix__softmax_full_mha__sliding_local_dilated__prompt_kernel_comb:
  v_mov_b32 v244, v240
  v_mov_b32 v245, v240
  s_nop 1
  v_permlane32_swap_b32 v244, v245
  v_add_f32 v10, |v232|, |v233|
  v_add_f32 v10, v10, |v234|
  v_add_f32 v10, v10, |v235|
  v_add_f32 v10, v10, |v236|
  v_add_f32 v10, v10, |v237|
  v_add_f32 v10, v10, |v238|
  v_add_f32 v10, v10, |v239|
  v_add_f32 v11, |v240|, |v241|
  v_add_f32 v11, v11, |v242|
  v_add_f32 v11, v11, |v243|
  v_cndmask_b32 v11, 0, v11, s[32:33]
  v_add_f32 v10, v10, v11
  v_mov_b32 v11, 0x7e800000
  v_cmp_nlt_f32 s[50:51], v10, v11
  v_mov_b32 v11, 0x17800000
  v_cmp_nge_f32 s[52:53], v245, v11
  v_mov_b32 v11, 0x71800000
  v_cmp_nle_f32 s[54:55], v245, v11
  s_nop 1
  s_or_b64 s[50:51], s[50:51], s[52:53]
  s_nop 0
  s_or_b64 s[50:51], s[50:51], s[54:55]
  s_cmp_eq_u64 s[50:51], 0
  s_cbranch_scc1 gated_mix__softmax_full_mha__sliding_local_dilated__prompt_kernel_ok
  v_mov_b32 v10, 1
  v_mov_b32 v11, 98304
  ds_write_b32 v11, v10
gated_mix__softmax_full_mha__sliding_local_dilated__prompt_kernel_ok:
  v_rcp_f32 v244, v245
  s_nop 0
  v_mul_f32 v244, v244, v216
  v_mul_f32 v232, v232, v244
  v_mul_f32 v233, v233, v244
  v_mul_f32 v234, v234, v244
  v_mul_f32 v235, v235, v244
  v_mul_f32 v236, v236, v244
  v_mul_f32 v237, v237, v244
  v_mul_f32 v238, v238, v244
  v_mul_f32 v239, v239, v244
  v_mul_f32 v240, v240, v244
  v_mul_f32 v241, v241, v244
  v_mul_f32 v242, v242, v244
  v_mul_f32 v243, v243, v244
  v_cvt_pk_bf16_f32 v246, v232, v233
  v_cvt_pk_bf16_f32 v247, v234, v235
  v_cvt_pk_bf16_f32 v248, v236, v237
  v_cvt_pk_bf16_f32 v249, v238, v239
  v_cvt_pk_bf16_f32 v250, v240, v241
  v_cvt_pk_bf16_f32 v251, v242, v243
  buffer_store_dwordx4 v[246:249], v14, s[16:19], 0 offen sc1
  s_mov_b64 exec, s[32:33]
  buffer_store_dwordx2 v[250:251], v1, s[16:19], 0 offen sc1
  s_mov_b64 exec, -1
gated_mix__softmax_full_mha__sliding_local_dilated__prompt_kernel_p2done:
  s_waitcnt vmcnt(0) lgkmcnt(0)
  s_barrier
  v_mov_b32 v11, 98304
  ds_read_b32 v10, v11
  s_waitcnt lgkmcnt(0)
  v_readfirstlane_b32 s8, v10
  s_nop 3
  s_cmp_lg_u32 s8, 0
  s_cbranch_scc1 gated_mix__softmax_full_mha__sliding_local_dilated__prompt_kernel_safe
  s_cmp_lg_u32 s20, 0
  s_cbranch_scc1 gated_mix__softmax_full_mha__sliding_local_dilated__prompt_kernel_nofoa
  s_lshl_b32 s8, s22, 4
  s_add_u32 s8, s8, s21
  s_lshl_b32 s8, s8, 2
  s_add_u32 s8, s8, 26281984
  s_mov_b64 exec, 1
  v_mov_b32 v8, s66
  v_mov_b32 v9, 0
  buffer_store_dword v8, v9, s[16:19], s8 offen sc1
  s_mov_b64 exec, -1
gated_mix__softmax_full_mha__sliding_local_dilated__prompt_kernel_nofoa:
  s_mov_b64 exec, s[58:59]
  s_add_u32 m0, s65, 26624
  s_mov_b32 s9, 409600
  buffer_load_dwordx4 v221, s[44:47], s9 offen lds
  s_add_u32 m0, s65, 27584
  s_mov_b32 s9, 416000
  buffer_load_dwordx4 v221, s[44:47], s9 offen lds
  s_add_u32 m0, s65, 28544
  s_mov_b32 s9, 422400
  buffer_load_dwordx4 v221, s[44:47], s9 offen lds
  s_add_u32 m0, s65, 29504
  s_mov_b32 s9, 428800
  buffer_load_dwordx4 v221, s[44:47], s9 offen lds
  s_add_u32 m0, s65, 30464
  s_mov_b32 s9, 435200
  buffer_load_dwordx4 v221, s[44:47], s9 offen lds
  s_add_u32 m0, s65, 31424
  s_mov_b32 s9, 441600
  buffer_load_dwordx4 v221, s[44:47], s9 offen lds
  s_add_u32 m0, s65, 32384
  s_mov_b32 s9, 448000
  buffer_load_dwordx4 v221, s[44:47], s9 offen lds
  s_add_u32 m0, s65, 33344
  s_mov_b32 s9, 454400
  buffer_load_dwordx4 v221, s[44:47], s9 offen lds
  s_mov_b64 exec, -1
  ds_read_b64_tr_b16 v[100:101], v217 offset:0
  ds_read_b64_tr_b16 v[102:103], v217 offset:1536
  ds_read_b64_tr_b16 v[104:105], v217 offset:64
  ds_read_b64_tr_b16 v[106:107], v217 offset:1600
  ds_read_b64_tr_b16 v[108:109], v217 offset:128
  ds_read_b64_tr_b16 v[110:111], v217 offset:1664
  ds_read_b64_tr_b16 v[112:113], v217 offset:3840
  ds_read_b64_tr_b16 v[114:115], v217 offset:5376
  ds_read_b64_tr_b16 v[116:117], v217 offset:3904
  ds_read_b64_tr_b16 v[118:119], v217 offset:5440
  ds_read_b64_tr_b16 v[120:121], v217 offset:3968
  ds_read_b64_tr_b16 v[122:123], v217 offset:5504
  s_waitcnt lgkmcnt(6)
  v_mfma_f32_32x32x16_bf16 v[16:31], v[100:103], v[136:139], 0
  ds_read_b64_tr_b16 v[124:125], v217 offset:7680
  ds_read_b64_tr_b16 v[126:127], v217 offset:9216
  v_mfma_f32_32x32x16_bf16 v[32:47], v[104:107], v[136:139], 0
  ds_read_b64_tr_b16 v[128:129], v217 offset:7744
  ds_read_b64_tr_b16 v[130:131], v217 offset:9280
  v_mfma_f32_32x32x16_bf16 v[48:63], v[108:111], v[136:139], 0
  ds_read_b64_tr_b16 v[132:133], v217 offset:7808
  ds_read_b64_tr_b16 v[134:135], v217 offset:9344
  s_waitcnt lgkmcnt(6)
  v_mfma_f32_32x32x16_bf16 v[16:31], v[112:115], v[140:143], v[16:31]
  ds_read_b64_tr_b16 v[100:101], v217 offset:11520
  ds_read_b64_tr_b16 v[102:103], v217 offset:13056
  v_mfma_f32_32x32x16_bf16 v[32:47], v[116:119], v[140:143], v[32:47]
  ds_read_b64_tr_b16 v[104:105], v217 offset:11584
  ds_read_b64_tr_b16 v[106:107], v217 offset:13120
  v_mfma_f32_32x32x16_bf16 v[48:63], v[120:123], v[140:143], v[48:63]
  ds_read_b64_tr_b16 v[108:109], v217 offset:11648
  ds_read_b64_tr_b16 v[110:111], v217 offset:13184
  s_waitcnt lgkmcnt(6)
  v_mfma_f32_32x32x16_bf16 v[16:31], v[124:127], v[144:147], v[16:31]
  ds_read_b64_tr_b16 v[112:113], v218 offset:0
  ds_read_b64_tr_b16 v[114:115], v218 offset:3840
  v_mfma_f32_32x32x16_bf16 v[32:47], v[128:131], v[144:147], v[32:47]
  ds_read_b64_tr_b16 v[116:117], v218 offset:64
  ds_read_b64_tr_b16 v[118:119], v218 offset:3904
  v_mfma_f32_32x32x16_bf16 v[48:63], v[132:135], v[144:147], v[48:63]
  ds_read_b64_tr_b16 v[120:121], v218 offset:128
  ds_read_b64_tr_b16 v[122:123], v218 offset:3968
  s_waitcnt lgkmcnt(6)
  v_mfma_f32_32x32x16_bf16 v[16:31], v[100:103], v[148:151], v[16:31]
  v_mfma_f32_32x32x16_bf16 v[32:47], v[104:107], v[148:151], v[32:47]
  v_mfma_f32_32x32x16_bf16 v[48:63], v[108:111], v[148:151], v[48:63]
  s_waitcnt lgkmcnt(0)
  v_mfma_f32_32x32x16_bf16 v[16:31], v[112:115], v[152:155], v[16:31]
  v_mfma_f32_32x32x16_bf16 v[32:47], v[116:119], v[152:155], v[32:47]
  v_mfma_f32_32x32x16_bf16 v[48:63], v[120:123], v[152:155], v[48:63]
  s_barrier
  s_mov_b64 exec, s[58:59]
  s_add_u32 m0, s65, 102400
  s_mov_b32 s9, 0
  buffer_load_dwordx4 v221, s[60:63], s9 offen lds
  s_add_u32 m0, s65, 103360
  s_mov_b32 s9, 6400
  buffer_load_dwordx4 v221, s[60:63], s9 offen lds
  s_add_u32 m0, s65, 104320
  s_mov_b32 s9, 12800
  buffer_load_dwordx4 v221, s[60:63], s9 offen lds
  s_add_u32 m0, s65, 105280
  s_mov_b32 s9, 19200
  buffer_load_dwordx4 v221, s[60:63], s9 offen lds
  s_add_u32 m0, s65, 106240
  s_mov_b32 s9, 25600
  buffer_load_dwordx4 v221, s[60:63], s9 offen lds
  s_add_u32 m0, s65, 107200
  s_mov_b32 s9, 32000
  buffer_load_dwordx4 v221, s[60:63], s9 offen lds
  s_add_u32 m0, s65, 108160
  s_mov_b32 s9, 38400
  buffer_load_dwordx4 v221, s[60:63], s9 offen lds
  s_add_u32 m0, s65, 109120
  s_mov_b32 s9, 44800
  buffer_load_dwordx4 v221, s[60:63], s9 offen lds
  s_mov_b64 exec, -1
  s_waitcnt vmcnt(8)
  s_barrier
  ds_read_b64_tr_b16 v[100:101], v219 offset:0
  ds_read_b64_tr_b16 v[102:103], v219 offset:1536
  ds_read_b64_tr_b16 v[104:105], v219 offset:64
  ds_read_b64_tr_b16 v[106:107], v219 offset:1600
  ds_read_b64_tr_b16 v[108:109], v219 offset:128
  ds_read_b64_tr_b16 v[110:111], v219 offset:1664
  ds_read_b64_tr_b16 v[112:113], v219 offset:3840
  ds_read_b64_tr_b16 v[114:115], v219 offset:5376
  ds_read_b64_tr_b16 v[116:117], v219 offset:3904
  ds_read_b64_tr_b16 v[118:119], v219 offset:5440
  ds_read_b64_tr_b16 v[120:121], v219 offset:3968
  ds_read_b64_tr_b16 v[122:123], v219 offset:5504
  s_waitcnt lgkmcnt(6)
  v_mfma_f32_32x32x16_bf16 v[16:31], v[100:103], v[156:159], v[16:31]
  ds_read_b64_tr_b16 v[124:125], v219 offset:7680
  ds_read_b64_tr_b16 v[126:127], v219 offset:9216
  v_mfma_f32_32x32x16_bf16 v[32:47], v[104:107], v[156:159], v[32:47]
  ds_read_b64_tr_b16 v[128:129], v219 offset:7744
  ds_read_b64_tr_b16 v[130:131], v219 offset:9280
  v_mfma_f32_32x32x16_bf16 v[48:63], v[108:111], v[156:159], v[48:63]
  ds_read_b64_tr_b16 v[132:133], v219 offset:7808
  ds_read_b64_tr_b16 v[134:135], v219 offset:9344
  s_waitcnt lgkmcnt(6)
  v_mfma_f32_32x32x16_bf16 v[16:31], v[112:115], v[160:163], v[16:31]
  ds_read_b64_tr_b16 v[100:101], v219 offset:11520
  ds_read_b64_tr_b16 v[102:103], v219 offset:13056
  v_mfma_f32_32x32x16_bf16 v[32:47], v[116:119], v[160:163], v[32:47]
  ds_read_b64_tr_b16 v[104:105], v219 offset:11584
  ds_read_b64_tr_b16 v[106:107], v219 offset:13120
  v_mfma_f32_32x32x16_bf16 v[48:63], v[120:123], v[160:163], v[48:63]
  ds_read_b64_tr_b16 v[108:109], v219 offset:11648
  ds_read_b64_tr_b16 v[110:111], v219 offset:13184
  s_waitcnt lgkmcnt(6)
  v_mfma_f32_32x32x16_bf16 v[16:31], v[124:127], v[164:167], v[16:31]
  ds_read_b64_tr_b16 v[112:113], v220 offset:0
  ds_read_b64_tr_b16 v[114:115], v220 offset:3840
  v_mfma_f32_32x32x16_bf16 v[32:47], v[128:131], v[164:167], v[32:47]
  ds_read_b64_tr_b16 v[116:117], v220 offset:64
  ds_read_b64_tr_b16 v[118:119], v220 offset:3904
  v_mfma_f32_32x32x16_bf16 v[48:63], v[132:135], v[164:167], v[48:63]
  ds_read_b64_tr_b16 v[120:121], v220 offset:128
  ds_read_b64_tr_b16 v[122:123], v220 offset:3968
  s_waitcnt lgkmcnt(6)
  v_mfma_f32_32x32x16_bf16 v[16:31], v[100:103], v[168:171], v[16:31]
  v_mfma_f32_32x32x16_bf16 v[32:47], v[104:107], v[168:171], v[32:47]
  v_mfma_f32_32x32x16_bf16 v[48:63], v[108:111], v[168:171], v[48:63]
  s_waitcnt lgkmcnt(0)
  v_mfma_f32_32x32x16_bf16 v[16:31], v[112:115], v[172:175], v[16:31]
  v_mfma_f32_32x32x16_bf16 v[32:47], v[116:119], v[172:175], v[32:47]
  v_mfma_f32_32x32x16_bf16 v[48:63], v[120:123], v[172:175], v[48:63]
  s_barrier
  s_mov_b64 exec, s[58:59]
  s_add_u32 m0, s65, 26624
  s_mov_b32 s9, 409600
  buffer_load_dwordx4 v221, s[60:63], s9 offen lds
  s_add_u32 m0, s65, 27584
  s_mov_b32 s9, 416000
  buffer_load_dwordx4 v221, s[60:63], s9 offen lds
  s_add_u32 m0, s65, 28544
  s_mov_b32 s9, 422400
  buffer_load_dwordx4 v221, s[60:63], s9 offen lds
  s_add_u32 m0, s65, 29504
  s_mov_b32 s9, 428800
  buffer_load_dwordx4 v221, s[60:63], s9 offen lds
  s_add_u32 m0, s65, 30464
  s_mov_b32 s9, 435200
  buffer_load_dwordx4 v221, s[60:63], s9 offen lds
  s_add_u32 m0, s65, 31424
  s_mov_b32 s9, 441600
  buffer_load_dwordx4 v221, s[60:63], s9 offen lds
  s_add_u32 m0, s65, 32384
  s_mov_b32 s9, 448000
  buffer_load_dwordx4 v221, s[60:63], s9 offen lds
  s_add_u32 m0, s65, 33344
  s_mov_b32 s9, 454400
  buffer_load_dwordx4 v221, s[60:63], s9 offen lds
  s_mov_b64 exec, -1
  s_mul_i32 s8, s48, 30720
  s_add_u32 s8, s8, 102400
  v_lshlrev_b32 v12, 4, v2
  v_add_u32 v12, s8, v12
  s_cmp_lg_u32 s20, 0
  s_cbranch_scc1 gated_mix__softmax_full_mha__sliding_local_dilated__prompt_kernel_nopoa
  v_and_b32 v10, 15, v2
  v_lshlrev_b32 v10, 2, v10
  s_lshl_b32 s91, s64, 6
  s_add_u32 s91, s91, 26281984
  s_mov_b32 s90, 200000
gated_mix__softmax_full_mha__sliding_local_dilated__prompt_kernel_poa:
  buffer_load_dword v8, v10, s[16:19], s91 offen sc1
  s_waitcnt vmcnt(0)
  v_cmp_ne_u32 vcc, s66, v8
  s_nop 4
  s_cbranch_vccz gated_mix__softmax_full_mha__sliding_local_dilated__prompt_kernel_poa_ok
  s_sub_u32 s90, s90, 1
  s_cmp_eq_u32 s90, 0
  s_cbranch_scc1 gated_mix__softmax_full_mha__sliding_local_dilated__prompt_kernel_poa_ok
  s_sleep 1
  s_branch gated_mix__softmax_full_mha__sliding_local_dilated__prompt_kernel_poa
gated_mix__softmax_full_mha__sliding_local_dilated__prompt_kernel_poa_ok:
gated_mix__softmax_full_mha__sliding_local_dilated__prompt_kernel_nopoa:
  s_waitcnt vmcnt(0)
  s_barrier
  s_mov_b32 s9, 0
  buffer_load_dwordx4 v[176:179], v223, s[16:19], s9 offen sc1
  s_mov_b32 s9, 1024
  buffer_load_dwordx4 v[180:183], v223, s[16:19], s9 offen sc1
  s_mov_b32 s9, 163840
  buffer_load_dwordx4 v[184:187], v223, s[16:19], s9 offen sc1
  s_mov_b32 s9, 164864
  buffer_load_dwordx4 v[188:191], v223, s[16:19], s9 offen sc1
  s_mov_b32 s9, 0
  buffer_load_dwordx2 v[192:193], v224, s[16:19], s9 offen sc1
  buffer_load_dwordx2 v[194:195], v224, s[16:19], s9 offen offset:256 sc1
  s_mov_b32 s9, 1310720
  buffer_load_dwordx4 v[196:199], v223, s[16:19], s9 offen sc1
  s_mov_b32 s9, 1311744
  buffer_load_dwordx4 v[200:203], v223, s[16:19], s9 offen sc1
  s_mov_b32 s9, 1474560
  buffer_load_dwordx4 v[204:207], v223, s[16:19], s9 offen sc1
  s_mov_b32 s9, 1475584
  buffer_load_dwordx4 v[208:211], v223, s[16:19], s9 offen sc1
  s_mov_b32 s9, 1310720
  buffer_load_dwordx2 v[212:213], v224, s[16:19], s9 offen sc1
  buffer_load_dwordx2 v[214:215], v224, s[16:19], s9 offen offset:256 sc1
  ds_read_b64_tr_b16 v[100:101], v217 offset:0
  ds_read_b64_tr_b16 v[102:103], v217 offset:1536
  ds_read_b64_tr_b16 v[104:105], v217 offset:64
  ds_read_b64_tr_b16 v[106:107], v217 offset:1600
  ds_read_b64_tr_b16 v[108:109], v217 offset:128
  ds_read_b64_tr_b16 v[110:111], v217 offset:1664
  ds_read_b64_tr_b16 v[112:113], v217 offset:3840
  ds_read_b64_tr_b16 v[114:115], v217 offset:5376
  ds_read_b64_tr_b16 v[116:117], v217 offset:3904
  ds_read_b64_tr_b16 v[118:119], v217 offset:5440
  ds_read_b64_tr_b16 v[120:121], v217 offset:3968
  ds_read_b64_tr_b16 v[122:123], v217 offset:5504
  s_waitcnt vmcnt(11) lgkmcnt(6)
  v_mfma_f32_32x32x16_bf16 v[16:31], v[100:103], v[176:179], v[16:31]
  ds_read_b64_tr_b16 v[124:125], v217 offset:7680
  ds_read_b64_tr_b16 v[126:127], v217 offset:9216
  v_mfma_f32_32x32x16_bf16 v[32:47], v[104:107], v[176:179], v[32:47]
  ds_read_b64_tr_b16 v[128:129], v217 offset:7744
  ds_read_b64_tr_b16 v[130:131], v217 offset:9280
  v_mfma_f32_32x32x16_bf16 v[48:63], v[108:111], v[176:179], v[48:63]
  ds_read_b64_tr_b16 v[132:133], v217 offset:7808
  ds_read_b64_tr_b16 v[134:135], v217 offset:9344
  s_waitcnt vmcnt(10) lgkmcnt(6)
  v_mfma_f32_32x32x16_bf16 v[16:31], v[112:115], v[180:183], v[16:31]
  ds_read_b64_tr_b16 v[100:101], v217 offset:11520
  ds_read_b64_tr_b16 v[102:103], v217 offset:13056
  v_mfma_f32_32x32x16_bf16 v[32:47], v[116:119], v[180:183], v[32:47]
  ds_read_b64_tr_b16 v[104:105], v217 offset:11584
  ds_read_b64_tr_b16 v[106:107], v217 offset:13120
  v_mfma_f32_32x32x16_bf16 v[48:63], v[120:123], v[180:183], v[48:63]
  ds_read_b64_tr_b16 v[108:109], v217 offset:11648
  ds_read_b64_tr_b16 v[110:111], v217 offset:13184
  s_waitcnt vmcnt(9) lgkmcnt(6)
  v_mfma_f32_32x32x16_bf16 v[16:31], v[124:127], v[184:187], v[16:31]
  ds_read_b64_tr_b16 v[112:113], v218 offset:0
  ds_read_b64_tr_b16 v[114:115], v218 offset:3840
  v_mfma_f32_32x32x16_bf16 v[32:47], v[128:131], v[184:187], v[32:47]
  ds_read_b64_tr_b16 v[116:117], v218 offset:64
  ds_read_b64_tr_b16 v[118:119], v218 offset:3904
  v_mfma_f32_32x32x16_bf16 v[48:63], v[132:135], v[184:187], v[48:63]
  ds_read_b64_tr_b16 v[120:121], v218 offset:128
  ds_read_b64_tr_b16 v[122:123], v218 offset:3968
  s_waitcnt vmcnt(8) lgkmcnt(6)
  v_mfma_f32_32x32x16_bf16 v[16:31], v[100:103], v[188:191], v[16:31]
  v_mfma_f32_32x32x16_bf16 v[32:47], v[104:107], v[188:191], v[32:47]
  v_mfma_f32_32x32x16_bf16 v[48:63], v[108:111], v[188:191], v[48:63]
  s_waitcnt vmcnt(6) lgkmcnt(0)
  v_mfma_f32_32x32x16_bf16 v[16:31], v[112:115], v[192:195], v[16:31]
  v_mfma_f32_32x32x16_bf16 v[32:47], v[116:119], v[192:195], v[32:47]
  v_mfma_f32_32x32x16_bf16 v[48:63], v[120:123], v[192:195], v[48:63]
  s_barrier
  ds_read_b64_tr_b16 v[100:101], v219 offset:0
  ds_read_b64_tr_b16 v[102:103], v219 offset:1536
  ds_read_b64_tr_b16 v[104:105], v219 offset:64
  ds_read_b64_tr_b16 v[106:107], v219 offset:1600
  ds_read_b64_tr_b16 v[108:109], v219 offset:128
  ds_read_b64_tr_b16 v[110:111], v219 offset:1664
  ds_read_b64_tr_b16 v[112:113], v219 offset:3840
  ds_read_b64_tr_b16 v[114:115], v219 offset:5376
  ds_read_b64_tr_b16 v[116:117], v219 offset:3904
  ds_read_b64_tr_b16 v[118:119], v219 offset:5440
  ds_read_b64_tr_b16 v[120:121], v219 offset:3968
  ds_read_b64_tr_b16 v[122:123], v219 offset:5504
  s_waitcnt vmcnt(5) lgkmcnt(6)
  v_mfma_f32_32x32x16_bf16 v[16:31], v[100:103], v[196:199], v[16:31]
  ds_read_b64_tr_b16 v[124:125], v219 offset:7680
  ds_read_b64_tr_b16 v[126:127], v219 offset:9216
  v_mfma_f32_32x32x16_bf16 v[32:47], v[104:107], v[196:199], v[32:47]
  ds_read_b64_tr_b16 v[128:129], v219 offset:7744
  ds_read_b64_tr_b16 v[130:131], v219 offset:9280
  v_mfma_f32_32x32x16_bf16 v[48:63], v[108:111], v[196:199], v[48:63]
  ds_read_b64_tr_b16 v[132:133], v219 offset:7808
  ds_read_b64_tr_b16 v[134:135], v219 offset:9344
  s_waitcnt vmcnt(4) lgkmcnt(6)
  v_mfma_f32_32x32x16_bf16 v[16:31], v[112:115], v[200:203], v[16:31]
  ds_read_b64_tr_b16 v[100:101], v219 offset:11520
  ds_read_b64_tr_b16 v[102:103], v219 offset:13056
  v_mfma_f32_32x32x16_bf16 v[32:47], v[116:119], v[200:203], v[32:47]
  ds_read_b64_tr_b16 v[104:105], v219 offset:11584
  ds_read_b64_tr_b16 v[106:107], v219 offset:13120
  v_mfma_f32_32x32x16_bf16 v[48:63], v[120:123], v[200:203], v[48:63]
  ds_read_b64_tr_b16 v[108:109], v219 offset:11648
  ds_read_b64_tr_b16 v[110:111], v219 offset:13184
  s_waitcnt vmcnt(3) lgkmcnt(6)
  v_mfma_f32_32x32x16_bf16 v[16:31], v[124:127], v[204:207], v[16:31]
  ds_read_b64_tr_b16 v[112:113], v220 offset:0
  ds_read_b64_tr_b16 v[114:115], v220 offset:3840
  v_mfma_f32_32x32x16_bf16 v[32:47], v[128:131], v[204:207], v[32:47]
  ds_read_b64_tr_b16 v[116:117], v220 offset:64
  ds_read_b64_tr_b16 v[118:119], v220 offset:3904
  v_mfma_f32_32x32x16_bf16 v[48:63], v[132:135], v[204:207], v[48:63]
  ds_read_b64_tr_b16 v[120:121], v220 offset:128
  ds_read_b64_tr_b16 v[122:123], v220 offset:3968
  s_waitcnt vmcnt(2) lgkmcnt(6)
  v_mfma_f32_32x32x16_bf16 v[16:31], v[100:103], v[208:211], v[16:31]
  v_mfma_f32_32x32x16_bf16 v[32:47], v[104:107], v[208:211], v[32:47]
  v_mfma_f32_32x32x16_bf16 v[48:63], v[108:111], v[208:211], v[48:63]
  s_waitcnt vmcnt(0) lgkmcnt(0)
  v_mfma_f32_32x32x16_bf16 v[16:31], v[112:115], v[212:215], v[16:31]
  v_mfma_f32_32x32x16_bf16 v[32:47], v[116:119], v[212:215], v[32:47]
  v_mfma_f32_32x32x16_bf16 v[48:63], v[120:123], v[212:215], v[48:63]
  s_nop 7
  s_nop 3
  s_cmp_eq_u32 s49, 0
  s_cbranch_scc0 gated_mix__softmax_full_mha__sliding_local_dilated__prompt_kernel_red0_next
  ds_write_b128 v12, v[20:23] offset:9216
  ds_write_b128 v12, v[36:39] offset:10240
  ds_write_b128 v12, v[52:55] offset:11264
  ds_write_b128 v12, v[24:27] offset:18432
  ds_write_b128 v12, v[40:43] offset:19456
  ds_write_b128 v12, v[28:31] offset:24576
  ds_write_b128 v12, v[44:47] offset:25600
  s_waitcnt lgkmcnt(0)
  s_barrier
  ds_read_b128 v[64:67], v12 offset:0
  ds_read_b128 v[68:71], v12 offset:1024
  ds_read_b128 v[72:75], v12 offset:2048
  ds_read_b128 v[76:79], v12 offset:3072
  ds_read_b128 v[80:83], v12 offset:4096
  ds_read_b128 v[84:87], v12 offset:5120
  ds_read_b128 v[88:91], v12 offset:6144
  ds_read_b128 v[92:95], v12 offset:7168
  ds_read_b128 v[96:99], v12 offset:8192
  s_waitcnt lgkmcnt(0)
  v_add_f32 v64, v64, v76
  v_add_f32 v88, v88, v16
  v_add_f32 v65, v65, v77
  v_add_f32 v89, v89, v17
  v_add_f32 v66, v66, v78
  v_add_f32 v90, v90, v18
  v_add_f32 v67, v67, v79
  v_add_f32 v91, v91, v19
  v_add_f32 v68, v68, v80
  v_add_f32 v92, v92, v32
  v_add_f32 v69, v69, v81
  v_add_f32 v93, v93, v33
  v_add_f32 v70, v70, v82
  v_add_f32 v94, v94, v34
  v_add_f32 v71, v71, v83
  v_add_f32 v95, v95, v35
  v_add_f32 v72, v72, v84
  v_add_f32 v96, v96, v48
  v_add_f32 v73, v73, v85
  v_add_f32 v97, v97, v49
  v_add_f32 v74, v74, v86
  v_add_f32 v98, v98, v50
  v_add_f32 v75, v75, v87
  v_add_f32 v99, v99, v51
  v_add_f32 v64, v64, v88
  v_add_f32 v65, v65, v89
  v_add_f32 v66, v66, v90
  v_add_f32 v67, v67, v91
  v_add_f32 v68, v68, v92
  v_add_f32 v69, v69, v93
  v_add_f32 v70, v70, v94
  v_add_f32 v71, v71, v95
  v_add_f32 v72, v72, v96
  v_add_f32 v73, v73, v97
  v_add_f32 v74, v74, v98
  v_add_f32 v75, v75, v99
  s_branch gated_mix__softmax_full_mha__sliding_local_dilated__prompt_kernel_red_done
gated_mix__softmax_full_mha__sliding_local_dilated__prompt_kernel_red0_next:
  s_cmp_eq_u32 s49, 1
  s_cbranch_scc0 gated_mix__softmax_full_mha__sliding_local_dilated__prompt_kernel_red1_next
  ds_write_b128 v12, v[16:19] offset:0
  ds_write_b128 v12, v[32:35] offset:1024
  ds_write_b128 v12, v[48:51] offset:2048
  ds_write_b128 v12, v[24:27] offset:20480
  ds_write_b128 v12, v[40:43] offset:21504
  ds_write_b128 v12, v[28:31] offset:26624
  ds_write_b128 v12, v[44:47] offset:27648
  s_waitcnt lgkmcnt(0)
  s_barrier
  ds_read_b128 v[64:67], v12 offset:9216
  ds_read_b128 v[68:71], v12 offset:10240
  ds_read_b128 v[72:75], v12 offset:11264
  ds_read_b128 v[76:79], v12 offset:12288
  ds_read_b128 v[80:83], v12 offset:13312
  ds_read_b128 v[84:87], v12 offset:14336
  ds_read_b128 v[88:91], v12 offset:15360
  ds_read_b128 v[92:95], v12 offset:16384
  ds_read_b128 v[96:99], v12 offset:17408
  s_waitcnt lgkmcnt(0)
  v_add_f32 v64, v64, v76
  v_add_f32 v88, v88, v20
  v_add_f32 v65, v65, v77
  v_add_f32 v89, v89, v21
  v_add_f32 v66, v66, v78
  v_add_f32 v90, v90, v22
  v_add_f32 v67, v67, v79
  v_add_f32 v91, v91, v23
  v_add_f32 v68, v68, v80
  v_add_f32 v92, v92, v36
  v_add_f32 v69, v69, v81
  v_add_f32 v93, v93, v37
  v_add_f32 v70, v70, v82
  v_add_f32 v94, v94, v38
  v_add_f32 v71, v71, v83
  v_add_f32 v95, v95, v39
  v_add_f32 v72, v72, v84
  v_add_f32 v96, v96, v52
  v_add_f32 v73, v73, v85
  v_add_f32 v97, v97, v53
  v_add_f32 v74, v74, v86
  v_add_f32 v98, v98, v54
  v_add_f32 v75, v75, v87
  v_add_f32 v99, v99, v55
  v_add_f32 v64, v64, v88
  v_add_f32 v65, v65, v89
  v_add_f32 v66, v66, v90
  v_add_f32 v67, v67, v91
  v_add_f32 v68, v68, v92
  v_add_f32 v69, v69, v93
  v_add_f32 v70, v70, v94
  v_add_f32 v71, v71, v95
  v_add_f32 v72, v72, v96
  v_add_f32 v73, v73, v97
  v_add_f32 v74, v74, v98
  v_add_f32 v75, v75, v99
  s_branch gated_mix__softmax_full_mha__sliding_local_dilated__prompt_kernel_red_done
gated_mix__softmax_full_mha__sliding_local_dilated__prompt_kernel_red1_next:
  s_cmp_eq_u32 s49, 2
  s_cbranch_scc0 gated_mix__softmax_full_mha__sliding_local_dilated__prompt_kernel_red2_next
  ds_write_b128 v12, v[16:19] offset:3072
  ds_write_b128 v12, v[32:35] offset:4096
  ds_write_b128 v12, v[48:51] offset:5120
  ds_write_b128 v12, v[20:23] offset:12288
  ds_write_b128 v12, v[36:39] offset:13312
  ds_write_b128 v12, v[52:55] offset:14336
  ds_write_b128 v12, v[28:31] offset:28672
  ds_write_b128 v12, v[44:47] offset:29696
  s_waitcnt lgkmcnt(0)
  s_barrier
  ds_read_b128 v[64:67], v12 offset:18432
  ds_read_b128 v[68:71], v12 offset:19456
  ds_read_b128 v[76:79], v12 offset:20480
  ds_read_b128 v[80:83], v12 offset:21504
  ds_read_b128 v[88:91], v12 offset:22528
  ds_read_b128 v[92:95], v12 offset:23552
  s_waitcnt lgkmcnt(0)
  v_add_f32 v64, v64, v76
  v_add_f32 v88, v88, v24
  v_add_f32 v65, v65, v77
  v_add_f32 v89, v89, v25
  v_add_f32 v66, v66, v78
  v_add_f32 v90, v90, v26
  v_add_f32 v67, v67, v79
  v_add_f32 v91, v91, v27
  v_add_f32 v68, v68, v80
  v_add_f32 v92, v92, v40
  v_add_f32 v69, v69, v81
  v_add_f32 v93, v93, v41
  v_add_f32 v70, v70, v82
  v_add_f32 v94, v94, v42
  v_add_f32 v71, v71, v83
  v_add_f32 v95, v95, v43
  v_add_f32 v64, v64, v88
  v_add_f32 v65, v65, v89
  v_add_f32 v66, v66, v90
  v_add_f32 v67, v67, v91
  v_add_f32 v68, v68, v92
  v_add_f32 v69, v69, v93
  v_add_f32 v70, v70, v94
  v_add_f32 v71, v71, v95
  s_branch gated_mix__softmax_full_mha__sliding_local_dilated__prompt_kernel_red_done
gated_mix__softmax_full_mha__sliding_local_dilated__prompt_kernel_red2_next:
  ds_write_b128 v12, v[16:19] offset:6144
  ds_write_b128 v12, v[32:35] offset:7168
  ds_write_b128 v12, v[48:51] offset:8192
  ds_write_b128 v12, v[20:23] offset:15360
  ds_write_b128 v12, v[36:39] offset:16384
  ds_write_b128 v12, v[52:55] offset:17408
  ds_write_b128 v12, v[24:27] offset:22528
  ds_write_b128 v12, v[40:43] offset:23552
  s_waitcnt lgkmcnt(0)
  s_barrier
  ds_read_b128 v[64:67], v12 offset:24576
  ds_read_b128 v[68:71], v12 offset:25600
  ds_read_b128 v[76:79], v12 offset:26624
  ds_read_b128 v[80:83], v12 offset:27648
  ds_read_b128 v[88:91], v12 offset:28672
  ds_read_b128 v[92:95], v12 offset:29696
  s_waitcnt lgkmcnt(0)
  v_add_f32 v64, v64, v76
  v_add_f32 v88, v88, v28
  v_add_f32 v65, v65, v77
  v_add_f32 v89, v89, v29
  v_add_f32 v66, v66, v78
  v_add_f32 v90, v90, v30
  v_add_f32 v67, v67, v79
  v_add_f32 v91, v91, v31
  v_add_f32 v68, v68, v80
  v_add_f32 v92, v92, v44
  v_add_f32 v69, v69, v81
  v_add_f32 v93, v93, v45
  v_add_f32 v70, v70, v82
  v_add_f32 v94, v94, v46
  v_add_f32 v71, v71, v83
  v_add_f32 v95, v95, v47
  v_add_f32 v64, v64, v88
  v_add_f32 v65, v65, v89
  v_add_f32 v66, v66, v90
  v_add_f32 v67, v67, v91
  v_add_f32 v68, v68, v92
  v_add_f32 v69, v69, v93
  v_add_f32 v70, v70, v94
  v_add_f32 v71, v71, v95
gated_mix__softmax_full_mha__sliding_local_dilated__prompt_kernel_red_done:
  v_cvt_pk_bf16_f32 v16, v64, v65
  v_cvt_pk_bf16_f32 v17, v66, v67
  v_cvt_pk_bf16_f32 v18, v68, v69
  v_cvt_pk_bf16_f32 v19, v70, v71
  v_cvt_pk_bf16_f32 v20, v72, v73
  v_cvt_pk_bf16_f32 v21, v74, v75
  v_permlane32_swap_b32 v16, v18
  v_permlane32_swap_b32 v17, v19
  v_lshrrev_b32 v9, 5, v2
  v_lshlrev_b32 v10, 6, v9
  v_add_u32 v10, v222, v10
  buffer_store_dwordx4 v[16:19], v10, s[96:99], 0 offen
  s_cmp_ge_u32 s49, 2
  s_cbranch_scc1 gated_mix__softmax_full_mha__sliding_local_dilated__prompt_kernel_fin
  v_lshlrev_b32 v10, 3, v9
  v_add_u32 v10, v222, v10
  buffer_store_dwordx2 v[20:21], v10, s[96:99], 0 offen offset:128
gated_mix__softmax_full_mha__sliding_local_dilated__prompt_kernel_fin:
  s_endpgm
gated_mix__softmax_full_mha__sliding_local_dilated__prompt_kernel_safe:
  s_waitcnt vmcnt(0) lgkmcnt(0)
  s_barrier
  v_mov_b32 v10, 0
  v_mov_b32 v11, 98304
  ds_write_b32 v11, v10
  s_mul_i32 s9, s25, 22528
  v_subrev_u32 v244, s9, v3
  v_subrev_u32 v245, s9, v4
  s_lshl_b32 s8, s22, 2
  s_lshl_b32 s9, s24, 1
  s_add_u32 s8, s8, s9
  s_mul_i32 s8, s8, 2560
  s_mul_i32 s9, s21, 163840
  s_add_u32 s8, s8, s9
  s_add_u32 s8, s8, 0
  s_add_u32 s9, s8, 2560
  buffer_load_dwordx4 v[16:19], v244, s[16:19], s8 offen sc1
  buffer_load_dwordx2 v[24:25], v245, s[16:19], s8 offen sc1
  buffer_load_dwordx4 v[20:23], v244, s[16:19], s9 offen sc1
  buffer_load_dwordx2 v[26:27], v245, s[16:19], s9 offen sc1
  s_waitcnt vmcnt(0)
  v_and_b32 v24, v228, v24
  v_and_b32 v25, v228, v25
  v_and_b32 v26, v228, v26
  v_and_b32 v27, v228, v27
  s_mov_b32 s27, s26
  s_add_u32 s30, s27, 0
  s_add_u32 m0, s28, 0
  s_nop 0
  buffer_load_dwordx4 v6, s[16:19], s30 offen sc1 lds
  s_add_u32 s30, s27, 8192
  s_add_u32 m0, s28, 8192
  s_nop 0
  buffer_load_dwordx4 v6, s[16:19], s30 offen sc1 lds
  s_add_u32 s30, s27, 16384
  s_add_u32 m0, s28, 16384
  s_nop 0
  buffer_load_dwordx4 v6, s[16:19], s30 offen sc1 lds
  s_add_u32 s30, s27, 24576
  s_add_u32 m0, s28, 24576
  s_nop 0
  buffer_load_dwordx4 v6, s[16:19], s30 offen sc1 lds
  s_add_u32 s30, s27, 32768
  s_add_u32 m0, s28, 32768
  s_nop 0
  buffer_load_dwordx4 v6, s[16:19], s30 offen sc1 lds
  s_mov_b32 exec_hi, 0
  s_add_u32 m0, s38, 0
  s_nop 0
  buffer_load_dwordx4 v7, s[16:19], s27 offen sc1 lds
  s_mov_b64 exec, -1
  s_add_u32 s27, s27, 45056
  v_mov_b32 v104, 0
  v_mov_b32 v105, 0
  v_mov_b32 v106, 0
  v_mov_b32 v107, 0
  v_mov_b32 v108, 0
  v_mov_b32 v109, 0
  v_mov_b32 v110, 0
  v_mov_b32 v111, 0
  v_mov_b32 v112, 0
  v_mov_b32 v113, 0
  v_mov_b32 v114, 0
  v_mov_b32 v115, 0
  v_mov_b32 v116, 0
  v_mov_b32 v117, 0
  v_mov_b32 v118, 0
  v_mov_b32 v119, 0
  v_mov_b32 v120, 0
  v_mov_b32 v121, 0
  v_mov_b32 v122, 0
  v_mov_b32 v123, 0
  v_mov_b32 v124, 0
  v_mov_b32 v125, 0
  v_mov_b32 v126, 0
  v_mov_b32 v127, 0
  v_mov_b32 v128, 0
  v_mov_b32 v129, 0
  v_mov_b32 v130, 0
  v_mov_b32 v131, 0
  v_mov_b32 v132, 0
  v_mov_b32 v133, 0
  v_mov_b32 v134, 0
  v_mov_b32 v135, 0
  v_mov_b32 v252, 0xff61b1e6
  v_mov_b32 v253, 0xff61b1e6
  s_mov_b32 s29, 0
  s_mov_b32 s31, 0
  v_mov_b32 v254, v3
  v_mov_b32 v255, v4
  v_mov_b32 v13, v5
gated_mix__softmax_full_mha__sliding_local_dilated__prompt_kernel_sloop:
  s_waitcnt vmcnt(0) lgkmcnt(0)
  s_barrier
  s_cmp_ge_u32 s29, 7
  s_cbranch_scc1 gated_mix__softmax_full_mha__sliding_local_dilated__prompt_kernel_snodma
  s_sub_u32 s8, 45056, s31
  s_add_u32 s8, s8, s28
  s_add_u32 s30, s27, 0
  s_add_u32 m0, s8, 0
  s_nop 0
  buffer_load_dwordx4 v6, s[16:19], s30 offen sc1 lds
  s_add_u32 s30, s27, 8192
  s_add_u32 m0, s8, 8192
  s_nop 0
  buffer_load_dwordx4 v6, s[16:19], s30 offen sc1 lds
  s_add_u32 s30, s27, 16384
  s_add_u32 m0, s8, 16384
  s_nop 0
  buffer_load_dwordx4 v6, s[16:19], s30 offen sc1 lds
  s_add_u32 s30, s27, 24576
  s_add_u32 m0, s8, 24576
  s_nop 0
  buffer_load_dwordx4 v6, s[16:19], s30 offen sc1 lds
  s_add_u32 s30, s27, 32768
  s_add_u32 m0, s8, 32768
  s_nop 0
  buffer_load_dwordx4 v6, s[16:19], s30 offen sc1 lds
  s_mov_b32 exec_hi, 0
  s_sub_u32 m0, s8, s28
  s_add_u32 m0, m0, s38
  s_nop 0
  buffer_load_dwordx4 v7, s[16:19], s27 offen sc1 lds
  s_mov_b64 exec, -1
  s_add_u32 s27, s27, 45056
gated_mix__softmax_full_mha__sliding_local_dilated__prompt_kernel_snodma:
  s_mov_b32 s9, 0
gated_mix__softmax_full_mha__sliding_local_dilated__prompt_kernel_stile:
  ds_read_b128 v[28:31], v254
  ds_read_b64 v[32:33], v255
  ds_read_b128 v[40:43], v13
  ds_read_b128 v[44:47], v13 offset:768
  s_waitcnt lgkmcnt(0)
  v_mfma_f32_32x32x8bf16_1k v[72:87], v[32:33], v[24:25], 0
  v_mfma_f32_32x32x16_bf16 v[72:87], v[28:31], v[16:19], v[72:87]
  s_nop 11
  v_max3_f32 v10, v72, v73, v74
  v_max3_f32 v10, v10, v75, v76
  v_max3_f32 v10, v10, v77, v78
  v_max3_f32 v10, v10, v79, v80
  v_max3_f32 v10, v10, v81, v82
  v_max3_f32 v10, v10, v83, v84
  v_max3_f32 v10, v10, v85, v86
  v_max3_f32 v10, v10, v87, v252
  v_mov_b32 v11, v10
  s_nop 1
  v_permlane32_swap_b32 v10, v11
  v_max_f32 v10, v10, v11
  v_sub_f32 v11, v252, v10
  v_exp_f32 v11, v11
  v_mov_b32 v252, v10
  v_mul_f32 v104, v104, v11
  v_mul_f32 v105, v105, v11
  v_mul_f32 v106, v106, v11
  v_mul_f32 v107, v107, v11
  v_mul_f32 v108, v108, v11
  v_mul_f32 v109, v109, v11
  v_mul_f32 v110, v110, v11
  v_mul_f32 v111, v111, v11
  v_mul_f32 v112, v112, v11
  v_mul_f32 v113, v113, v11
  v_mul_f32 v114, v114, v11
  v_mul_f32 v115, v115, v11
  v_mul_f32 v116, v116, v11
  v_mul_f32 v117, v117, v11
  v_mul_f32 v118, v118, v11
  v_mul_f32 v119, v119, v11
  v_sub_f32 v72, v72, v10
  v_sub_f32 v73, v73, v10
  v_sub_f32 v74, v74, v10
  v_sub_f32 v75, v75, v10
  v_sub_f32 v76, v76, v10
  v_sub_f32 v77, v77, v10
  v_sub_f32 v78, v78, v10
  v_sub_f32 v79, v79, v10
  v_sub_f32 v80, v80, v10
  v_sub_f32 v81, v81, v10
  v_sub_f32 v82, v82, v10
  v_sub_f32 v83, v83, v10
  v_sub_f32 v84, v84, v10
  v_sub_f32 v85, v85, v10
  v_sub_f32 v86, v86, v10
  v_sub_f32 v87, v87, v10
  v_exp_f32 v72, v72
  v_exp_f32 v73, v73
  v_exp_f32 v74, v74
  v_exp_f32 v75, v75
  v_exp_f32 v76, v76
  v_exp_f32 v77, v77
  v_exp_f32 v78, v78
  v_exp_f32 v79, v79
  v_exp_f32 v80, v80
  v_exp_f32 v81, v81
  v_exp_f32 v82, v82
  v_exp_f32 v83, v83
  v_exp_f32 v84, v84
  v_exp_f32 v85, v85
  v_exp_f32 v86, v86
  v_exp_f32 v87, v87
  v_cvt_pk_bf16_f32 v56, v72, v73
  v_cvt_pk_bf16_f32 v57, v74, v75
  v_cvt_pk_bf16_f32 v58, v76, v77
  v_cvt_pk_bf16_f32 v59, v78, v79
  v_cvt_pk_bf16_f32 v60, v80, v81
  v_cvt_pk_bf16_f32 v61, v82, v83
  v_cvt_pk_bf16_f32 v62, v84, v85
  v_cvt_pk_bf16_f32 v63, v86, v87
  v_mfma_f32_32x32x16_bf16 v[104:119], v[40:43], v[56:59], v[104:119]
  s_nop 0
  v_mfma_f32_32x32x16_bf16 v[104:119], v[44:47], v[60:63], v[104:119]
  v_mfma_f32_32x32x8bf16_1k v[72:87], v[32:33], v[26:27], 0
  v_mfma_f32_32x32x16_bf16 v[72:87], v[28:31], v[20:23], v[72:87]
  s_nop 11
  v_max3_f32 v10, v72, v73, v74
  v_max3_f32 v10, v10, v75, v76
  v_max3_f32 v10, v10, v77, v78
  v_max3_f32 v10, v10, v79, v80
  v_max3_f32 v10, v10, v81, v82
  v_max3_f32 v10, v10, v83, v84
  v_max3_f32 v10, v10, v85, v86
  v_max3_f32 v10, v10, v87, v253
  v_mov_b32 v11, v10
  s_nop 1
  v_permlane32_swap_b32 v10, v11
  v_max_f32 v10, v10, v11
  v_sub_f32 v11, v253, v10
  v_exp_f32 v11, v11
  v_mov_b32 v253, v10
  v_mul_f32 v120, v120, v11
  v_mul_f32 v121, v121, v11
  v_mul_f32 v122, v122, v11
  v_mul_f32 v123, v123, v11
  v_mul_f32 v124, v124, v11
  v_mul_f32 v125, v125, v11
  v_mul_f32 v126, v126, v11
  v_mul_f32 v127, v127, v11
  v_mul_f32 v128, v128, v11
  v_mul_f32 v129, v129, v11
  v_mul_f32 v130, v130, v11
  v_mul_f32 v131, v131, v11
  v_mul_f32 v132, v132, v11
  v_mul_f32 v133, v133, v11
  v_mul_f32 v134, v134, v11
  v_mul_f32 v135, v135, v11
  v_sub_f32 v72, v72, v10
  v_sub_f32 v73, v73, v10
  v_sub_f32 v74, v74, v10
  v_sub_f32 v75, v75, v10
  v_sub_f32 v76, v76, v10
  v_sub_f32 v77, v77, v10
  v_sub_f32 v78, v78, v10
  v_sub_f32 v79, v79, v10
  v_sub_f32 v80, v80, v10
  v_sub_f32 v81, v81, v10
  v_sub_f32 v82, v82, v10
  v_sub_f32 v83, v83, v10
  v_sub_f32 v84, v84, v10
  v_sub_f32 v85, v85, v10
  v_sub_f32 v86, v86, v10
  v_sub_f32 v87, v87, v10
  v_exp_f32 v72, v72
  v_exp_f32 v73, v73
  v_exp_f32 v74, v74
  v_exp_f32 v75, v75
  v_exp_f32 v76, v76
  v_exp_f32 v77, v77
  v_exp_f32 v78, v78
  v_exp_f32 v79, v79
  v_exp_f32 v80, v80
  v_exp_f32 v81, v81
  v_exp_f32 v82, v82
  v_exp_f32 v83, v83
  v_exp_f32 v84, v84
  v_exp_f32 v85, v85
  v_exp_f32 v86, v86
  v_exp_f32 v87, v87
  v_cvt_pk_bf16_f32 v56, v72, v73
  v_cvt_pk_bf16_f32 v57, v74, v75
  v_cvt_pk_bf16_f32 v58, v76, v77
  v_cvt_pk_bf16_f32 v59, v78, v79
  v_cvt_pk_bf16_f32 v60, v80, v81
  v_cvt_pk_bf16_f32 v61, v82, v83
  v_cvt_pk_bf16_f32 v62, v84, v85
  v_cvt_pk_bf16_f32 v63, v86, v87
  v_mfma_f32_32x32x16_bf16 v[120:135], v[40:43], v[56:59], v[120:135]
  s_nop 0
  v_mfma_f32_32x32x16_bf16 v[120:135], v[44:47], v[60:63], v[120:135]
  v_add_u32 v254, 5632, v254
  v_add_u32 v255, 5632, v255
  v_add_u32 v13, 5632, v13
  s_add_u32 s9, s9, 1
  s_cmp_lt_u32 s9, 4
  s_nop 7
  s_cbranch_scc1 gated_mix__softmax_full_mha__sliding_local_dilated__prompt_kernel_stile
  s_sub_u32 s31, 45056, s31
  v_add_u32 v254, s31, v3
  v_add_u32 v255, s31, v4
  v_add_u32 v13, s31, v5
  s_add_u32 s29, s29, 1
  s_cmp_lt_u32 s29, 8
  s_cbranch_scc1 gated_mix__softmax_full_mha__sliding_local_dilated__prompt_kernel_sloop
  s_nop 7
  s_nop 3
  s_barrier
  s_cmp_eq_u32 s25, 0
  s_cbranch_scc0 gated_mix__softmax_full_mha__sliding_local_dilated__prompt_kernel_sh1
  ds_write_b128 v15, v[120:123] offset:0
  ds_write_b128 v15, v[124:127] offset:1024
  ds_write_b128 v15, v[128:131] offset:2048
  v_lshlrev_b32 v12, 2, v2
  s_mul_i32 s8, s20, 3328
  s_add_u32 s8, s8, 3072
  v_add_u32 v12, s8, v12
  ds_write_b32 v12, v253
  s_xor_b32 s8, s20, 4
  s_sub_i32 s8, s8, s20
  s_mul_i32 s8, s8, 3328
  v_add_u32 v10, s8, v15
  v_add_u32 v12, s8, v12
  s_waitcnt lgkmcnt(0)
  s_barrier
  ds_read_b128 v[232:235], v10 offset:0
  ds_read_b128 v[236:239], v10 offset:1024
  ds_read_b128 v[240:243], v10 offset:2048
  ds_read_b32 v13, v12
  s_waitcnt lgkmcnt(0)
  v_max_f32 v10, v252, v13
  v_sub_f32 v11, v252, v10
  v_sub_f32 v12, v13, v10
  v_exp_f32 v11, v11
  v_exp_f32 v12, v12
  s_nop 0
  v_mul_f32 v232, v232, v12
  v_mul_f32 v233, v233, v12
  v_mul_f32 v234, v234, v12
  v_mul_f32 v235, v235, v12
  v_mul_f32 v236, v236, v12
  v_mul_f32 v237, v237, v12
  v_mul_f32 v238, v238, v12
  v_mul_f32 v239, v239, v12
  v_mul_f32 v240, v240, v12
  v_mul_f32 v241, v241, v12
  v_mul_f32 v242, v242, v12
  v_mul_f32 v243, v243, v12
  v_fmac_f32 v232, v104, v11
  v_fmac_f32 v233, v105, v11
  v_fmac_f32 v234, v106, v11
  v_fmac_f32 v235, v107, v11
  v_fmac_f32 v236, v108, v11
  v_fmac_f32 v237, v109, v11
  v_fmac_f32 v238, v110, v11
  v_fmac_f32 v239, v111, v11
  v_fmac_f32 v240, v112, v11
  v_fmac_f32 v241, v113, v11
  v_fmac_f32 v242, v114, v11
  v_fmac_f32 v243, v115, v11
  s_branch gated_mix__softmax_full_mha__sliding_local_dilated__prompt_kernel_scomb
gated_mix__softmax_full_mha__sliding_local_dilated__prompt_kernel_sh1:
  ds_write_b128 v15, v[104:107] offset:0
  ds_write_b128 v15, v[108:111] offset:1024
  ds_write_b128 v15, v[112:115] offset:2048
  v_lshlrev_b32 v12, 2, v2
  s_mul_i32 s8, s20, 3328
  s_add_u32 s8, s8, 3072
  v_add_u32 v12, s8, v12
  ds_write_b32 v12, v252
  s_xor_b32 s8, s20, 4
  s_sub_i32 s8, s8, s20
  s_mul_i32 s8, s8, 3328
  v_add_u32 v10, s8, v15
  v_add_u32 v12, s8, v12
  s_waitcnt lgkmcnt(0)
  s_barrier
  ds_read_b128 v[232:235], v10 offset:0
  ds_read_b128 v[236:239], v10 offset:1024
  ds_read_b128 v[240:243], v10 offset:2048
  ds_read_b32 v13, v12
  s_waitcnt lgkmcnt(0)
  v_max_f32 v10, v253, v13
  v_sub_f32 v11, v253, v10
  v_sub_f32 v12, v13, v10
  v_exp_f32 v11, v11
  v_exp_f32 v12, v12
  s_nop 0
  v_mul_f32 v232, v232, v12
  v_mul_f32 v233, v233, v12
  v_mul_f32 v234, v234, v12
  v_mul_f32 v235, v235, v12
  v_mul_f32 v236, v236, v12
  v_mul_f32 v237, v237, v12
  v_mul_f32 v238, v238, v12
  v_mul_f32 v239, v239, v12
  v_mul_f32 v240, v240, v12
  v_mul_f32 v241, v241, v12
  v_mul_f32 v242, v242, v12
  v_mul_f32 v243, v243, v12
  v_fmac_f32 v232, v120, v11
  v_fmac_f32 v233, v121, v11
  v_fmac_f32 v234, v122, v11
  v_fmac_f32 v235, v123, v11
  v_fmac_f32 v236, v124, v11
  v_fmac_f32 v237, v125, v11
  v_fmac_f32 v238, v126, v11
  v_fmac_f32 v239, v127, v11
  v_fmac_f32 v240, v128, v11
  v_fmac_f32 v241, v129, v11
  v_fmac_f32 v242, v130, v11
  v_fmac_f32 v243, v131, v11
gated_mix__softmax_full_mha__sliding_local_dilated__prompt_kernel_scomb:
  v_mov_b32 v244, v240
  v_mov_b32 v245, v240
  s_nop 1
  v_permlane32_swap_b32 v244, v245
  v_rcp_f32 v244, v245
  s_nop 0
  v_mul_f32 v244, v244, v216
  v_mul_f32 v232, v232, v244
  v_mul_f32 v233, v233, v244
  v_mul_f32 v234, v234, v244
  v_mul_f32 v235, v235, v244
  v_mul_f32 v236, v236, v244
  v_mul_f32 v237, v237, v244
  v_mul_f32 v238, v238, v244
  v_mul_f32 v239, v239, v244
  v_mul_f32 v240, v240, v244
  v_mul_f32 v241, v241, v244
  v_mul_f32 v242, v242, v244
  v_mul_f32 v243, v243, v244
  v_cvt_pk_bf16_f32 v246, v232, v233
  v_cvt_pk_bf16_f32 v247, v234, v235
  v_cvt_pk_bf16_f32 v248, v236, v237
  v_cvt_pk_bf16_f32 v249, v238, v239
  v_cvt_pk_bf16_f32 v250, v240, v241
  v_cvt_pk_bf16_f32 v251, v242, v243
  buffer_store_dwordx4 v[246:249], v14, s[16:19], 0 offen sc1
  s_mov_b64 exec, s[32:33]
  buffer_store_dwordx2 v[250:251], v1, s[16:19], 0 offen sc1
  s_mov_b64 exec, -1
  s_waitcnt lgkmcnt(0)
  s_barrier
  s_branch gated_mix__softmax_full_mha__sliding_local_dilated__prompt_kernel_p2done
gated_mix__softmax_full_mha__sliding_local_dilated__prompt_kernel_end:
  s_endpgm
text_end:
.section .rodata,"a"
.p2align 6
.amdhsa_kernel gated_mix__softmax_full_mha__sliding_local_dilated__prompt_kernel
  .amdhsa_next_free_vgpr 256
  .amdhsa_next_free_sgpr 102
  .amdhsa_accum_offset 256
  .amdhsa_group_segment_fixed_size 0
  .amdhsa_kernarg_size 80
  .amdhsa_user_sgpr_count 2
  .amdhsa_user_sgpr_kernarg_segment_ptr 1
  .amdhsa_system_sgpr_workgroup_id_x 1
  .amdhsa_float_denorm_mode_32 3
.end_amdhsa_kernel
```
